```python
import torch

def _softmax(x, axis=-1):
    return torch.softmax(x, dim=axis)
def _gelu(x):
    return torch.nn.functional.gelu(x, approximate="tanh")
def _silu(x):
    return torch.nn.functional.silu(x)
def _sigmoid(x):
    return torch.sigmoid(x)
def _layernorm(x, axis=-1, eps=1e-5):
    m = x.mean(dim=axis, keepdim=True)
    v = x.var(dim=axis, keepdim=True, unbiased=False)
    return (x - m) / torch.sqrt(v + eps)
def _scatter_add(tgt, idx, src, axis=0):
    return tgt.clone().index_add_(axis, idx, src)
def _segment_sum(src, seg, n):
    out = torch.zeros((n,) + src.shape[1:], dtype=src.dtype)
    return out.index_add_(0, seg, src)
def _pad(x, pw):
    flat = tuple(v for pair in reversed(pw) for v in pair)
    return torch.nn.functional.pad(x, flat)

kernel_name = 'sequential_preLN__ssm_conv_h3__glu_gated_glu__prompt'

def setup_inputs():

    _w = (lambda a: (lambda t: t.to(torch.bfloat16) if t.is_floating_point() else t)(torch.as_tensor(a)))
    def _A_setup():
        B, S, D = 1, 2048, 512
        ks = 4
        return {
            "q": _w((lambda *s: torch.randn(*s, dtype=torch.bfloat16) * 0.05)(B, S, D)),
            "k": _w((lambda *s: torch.randn(*s, dtype=torch.bfloat16) * 0.4)(B, S, D)),
            "v": _w((lambda *s: torch.randn(*s, dtype=torch.bfloat16) * 0.4)(B, S, D)),
            "shift_k": _w((lambda *s: torch.randn(*s, dtype=torch.bfloat16) * 0.4)(D, ks) * 0.5),
            "ssm_k": _w((lambda *s: torch.randn(*s, dtype=torch.bfloat16) * 0.4)(D, S) * (1.0 / S ** 0.5)),
            "ssm_D": _w((lambda *s: torch.randn(*s, dtype=torch.bfloat16) * 0.4)(D)),
        }
    _A_in = _A_setup()

    def _B_setup():
        B, S, D, F = 1, 2048, 512, 1792
        return {
            "x": _w((lambda *s: torch.randn(*s, dtype=torch.bfloat16) * 0.05)(B, S, D)),
            "w_gate": _w((lambda *s: torch.randn(*s, dtype=torch.bfloat16) * 0.05)(D, F)),
            "w_up": _w((lambda *s: torch.randn(*s, dtype=torch.bfloat16) * 0.05)(D, F)),
            "w_down": _w((lambda *s: torch.randn(*s, dtype=torch.bfloat16) * 0.05)(F, D)),
        }
    _B_in = _B_setup()

    return {
        "A_q": _A_in["q"],
        "A_k": _A_in["k"],
        "A_v": _A_in["v"],
        "A_shift_k": _A_in["shift_k"],
        "A_ssm_k": _A_in["ssm_k"],
        "A_ssm_D": _A_in["ssm_D"],
        "B_x": _B_in["x"],
        "B_w_gate": _B_in["w_gate"],
        "B_w_up": _B_in["w_up"],
        "B_w_down": _B_in["w_down"],
    }

def reference(A_q, A_k, A_v, A_shift_k, A_ssm_k, A_ssm_D, B_x, B_w_gate, B_w_up, B_w_down):
    def _A_ref(q, k, v, shift_k, ssm_k, ssm_D):
        B, S, D = q.shape
        ks = shift_k.shape[-1]
        k_pad = _pad(k, ((0, 0), (ks - 1, 0), (0, 0)))
        k_shift = torch.zeros_like(k)
        for t in range(ks):
            k_shift = k_shift + k_pad[:, t:t + S, :] * shift_k[:, ks - 1 - t][None, None, :]
        kv = k_shift * v
        L = 2 * S
        kv_pad = _pad(kv, ((0, 0), (0, S), (0, 0)))
        kf_pad = _pad(ssm_k, ((0, 0), (0, S)))
        kv_f = (lambda x, axes=(-2,-1): torch.fft.rfft2(x.float(), dim=axes))(kv_pad[:, None, :, :], axes=(1, 2))
        kf_f = (lambda x, axes=(-2,-1): torch.fft.rfft2(x.float(), dim=axes))(kf_pad[:, None, :], axes=(1, 2))
        kf_f = (lambda x, *d: x.permute(*d))(kf_f, 1, 2, 0)
        y_f = kv_f * kf_f[None, :, :, :]
        y = (lambda x, s, axes=(-2,-1): torch.fft.irfft2(x, s=s, dim=axes).to(torch.bfloat16))(y_f, (1, L), axes=(1, 2))[:, 0, :S, :]
        y = y + kv * ssm_D[None, None, :]
        return q * y

    def _B_ref(x, w_gate, w_up, w_down):
        g = torch.einsum("bsd,df->bsf", x, w_gate)
        u = torch.einsum("bsd,df->bsf", x, w_up)
        h = _sigmoid(g) * u
        return torch.einsum("bsf,fd->bsd", h, w_down)

    x = A_q
    h = x + _A_ref(_layernorm(x, axis=-1), A_k, A_v, A_shift_k, A_ssm_k, A_ssm_D)
    h2 = h + _B_ref(_layernorm(h, axis=-1), B_w_gate, B_w_up, B_w_down)
    return h2
```

```asm
; @launch grid=(256,1,1) block=(256,1,1) lds=163840
.amdgcn_target "amdgcn-amd-amdhsa--gfx950"
.text
.globl sequential_preLN__ssm_conv_h3__glu_gated_glu__prompt_kernel
.p2align 8
.type sequential_preLN__ssm_conv_h3__glu_gated_glu__prompt_kernel,@function
sequential_preLN__ssm_conv_h3__glu_gated_glu__prompt_kernel:
 s_cmp_ge_u32 s2, 256
 s_cbranch_scc1 L_end
 s_load_dwordx2 s[12:13], s[0:1], 8
 s_load_dwordx2 s[16:17], s[0:1], 16
 s_load_dwordx2 s[20:21], s[0:1], 24
 s_getpc_b64 s[100:101]
L_pc:
 s_bfe_u32 s3, s2, 0x30003
 s_lshl_b32 s3, s3, 2
 v_lshrrev_b32 v12, 6, v0
 v_add_u32 v12, s3, v12
 v_mul_u32_u24 v12, 9, v12
 v_and_b32 v13, 63, v0
 v_min_u32 v13, 8, v13
 v_add_lshl_u32 v12, v12, v13, 7
 v_min_u32 v12, L_codeend-L_pc-4, v12
 global_load_dword v251, v12, s[100:101]
 s_load_dwordx2 s[48:49], s[0:1], 96
 s_load_dwordx2 s[24:25], s[0:1], 32
 s_load_dwordx2 s[8:9], s[0:1], 0
 s_load_dwordx2 s[28:29], s[0:1], 40
 s_and_b32 s3, s2, 7
 s_lshl_b32 s3, s3, 5
 s_lshr_b32 s96, s2, 3
 s_or_b32 s96, s96, s3
 v_and_b32 v1, 3, v0
 v_lshrrev_b32 v2, 2, v0
 s_lshl_b32 s3, s96, 13
 v_lshlrev_b32 v3, 11, v1
 v_lshl_add_u32 v3, v2, 4, v3
 v_add_u32 v3, s3, v3
 v_subrev_u32 v4, 3072, v3
 v_subrev_u32 v5, 2048, v3
 v_subrev_u32 v8, 1024, v3
 v_lshlrev_b32 v9, 4, v0
 s_mov_b32 s14, 2097152
 s_mov_b32 s15, 0x20000
 s_mov_b32 s18, 2097152
 s_mov_b32 s19, 0x20000
 s_mov_b32 s22, 4096
 s_mov_b32 s23, 0x20000
 s_waitcnt lgkmcnt(0)
 buffer_load_dwordx4 v[144:147], v4, s[12:15], 0 offen
 buffer_load_dwordx4 v[148:151], v5, s[12:15], 0 offen
 buffer_load_dwordx4 v[152:155], v8, s[12:15], 0 offen
 buffer_load_dwordx4 v[156:159], v3, s[12:15], 0 offen
 buffer_load_dwordx4 v[160:163], v3, s[12:15], 0 offen offset:1024
 buffer_load_dwordx4 v[180:183], v3, s[16:19], 0 offen
 buffer_load_dwordx4 v[184:187], v3, s[16:19], 0 offen offset:1024
 buffer_load_dwordx4 v[164:167], v9, s[20:23], 0 offen
 s_load_dword s61, s[48:49], 0
 s_load_dwordx2 s[40:41], s[0:1], 72
 s_load_dwordx2 s[32:33], s[0:1], 56
 s_load_dwordx2 s[36:37], s[0:1], 64
 s_load_dwordx2 s[44:45], s[0:1], 80
 v_lshrrev_b32 v6, 6, v0
 s_nop 0
 v_readfirstlane_b32 s56, v6
 v_and_b32 v6, 63, v0
 v_lshlrev_b32 v6, 4, v6
 s_lshl_b32 s97, s96, 1
 s_lshr_b32 s7, s56, 1
 s_add_u32 s97, s97, s7
 s_lshl_b32 s97, s97, 12
 s_mul_i32 s7, s56, 4160
 s_add_u32 s7, s7, 140288
 v_mov_b32 v12, 0
 s_and_b32 s3, s56, 1
 s_sub_u32 s4, 7, s3
 v_and_b32 v14, 7, v0
 v_min_u32 v14, s4, v14
 v_lshl_add_u32 v13, v14, 2, s7
 ds_write_b32 v13, v12
 s_lshl_b32 s3, s3, 2
 s_sub_u32 s54, s7, s3
 s_mul_i32 s4, s96, 16640
 s_add_u32 s4, s4, 1048576
 s_add_u32 s5, s4, 4096
 s_add_u32 s6, s4, 8192
 s_add_u32 s7, s4, 12288
 s_mov_b32 s62, 0x05040100
 s_mov_b32 s63, 0x07060302
 s_mov_b32 s64, 0xffff0000
 s_mov_b32 s75, 400000
 v_lshlrev_b32 v7, 4, v2
 s_mov_b32 s26, 2097152
 s_mov_b32 s27, 0x20000
 s_mov_b32 s50, 24117248
 s_mov_b32 s51, 0x20000
 s_mov_b32 s10, 2097152
 s_mov_b32 s11, 0x20000
 s_mov_b32 s30, 1024
 s_mov_b32 s31, 0x20000
 s_mov_b32 s42, 1835008
 s_mov_b32 s43, 0x20000
 v_mov_b32 v188, 0
 v_mov_b32 v189, 0
 v_mov_b32 v190, 0
 v_mov_b32 v191, 0
 v_mov_b32 v192, 0
 v_mov_b32 v193, 0
 v_mov_b32 v194, 0
 v_mov_b32 v195, 0
 v_mov_b32 v196, 0
 v_mov_b32 v197, 0
 v_mov_b32 v198, 0
 v_mov_b32 v199, 0
 v_mov_b32 v200, 0
 v_mov_b32 v201, 0
 v_mov_b32 v202, 0
 v_mov_b32 v203, 0
 s_add_u32 m0, s54, 32
 s_nop 0
 buffer_load_dwordx4 v6, s[24:27], s97 offen offset:0 lds
 buffer_load_dwordx4 v6, s[24:27], s97 offen offset:1024 lds
 buffer_load_dwordx4 v6, s[24:27], s97 offen offset:2048 lds
 buffer_load_dwordx4 v6, s[24:27], s97 offen offset:3072 lds
 buffer_load_dwordx4 v[240:243], v3, s[8:11], 0 offen
 buffer_load_dwordx4 v[244:247], v3, s[8:11], 0 offen offset:1024
 buffer_load_dwordx4 v[220:223], v7, s[28:31], 0 offen
 s_waitcnt lgkmcnt(0)
 s_add_u32 s61, s61, 0x9E3779B1
 v_mov_b32 v225, s61
 v_mov_b32 v227, s61
 v_mov_b32 v229, s61
 v_mov_b32 v231, s61
 v_mov_b32 v233, s61
 v_mov_b32 v235, s61
 v_mov_b32 v237, s61
 v_mov_b32 v239, s61
 s_waitcnt vmcnt(7)
 v_perm_b32 v204, v152, v156, s62
 v_perm_b32 v205, v144, v148, s62
 v_perm_b32 v206, v156, v160, s62
 v_perm_b32 v207, v148, v152, s62
 v_perm_b32 v208, v152, v156, s63
 v_perm_b32 v209, v144, v148, s63
 v_perm_b32 v210, v156, v160, s63
 v_perm_b32 v211, v148, v152, s63
 v_dot2c_f32_bf16_dpp v188, v165, v205 quad_perm:[0,0,0,0] row_mask:0xf bank_mask:0xf
 v_dot2c_f32_bf16_dpp v190, v165, v207 quad_perm:[0,0,0,0] row_mask:0xf bank_mask:0xf
 v_dot2c_f32_bf16_dpp v189, v167, v209 quad_perm:[0,0,0,0] row_mask:0xf bank_mask:0xf
 v_dot2c_f32_bf16_dpp v191, v167, v211 quad_perm:[0,0,0,0] row_mask:0xf bank_mask:0xf
 v_dot2c_f32_bf16_dpp v188, v164, v204 quad_perm:[0,0,0,0] row_mask:0xf bank_mask:0xf
 v_dot2c_f32_bf16_dpp v190, v164, v206 quad_perm:[0,0,0,0] row_mask:0xf bank_mask:0xf
 v_dot2c_f32_bf16_dpp v189, v166, v208 quad_perm:[0,0,0,0] row_mask:0xf bank_mask:0xf
 v_dot2c_f32_bf16_dpp v191, v166, v210 quad_perm:[0,0,0,0] row_mask:0xf bank_mask:0xf
 v_lshlrev_b32 v204, 16, v180
 v_and_b32 v205, s64, v180
 v_lshlrev_b32 v206, 16, v184
 v_and_b32 v207, s64, v184
 v_pk_mul_f32 v[188:189], v[188:189], v[204:205]
 v_pk_mul_f32 v[190:191], v[190:191], v[206:207]
 v_cvt_pk_bf16_f32 v224, v188, v189
 v_cvt_pk_bf16_f32 v226, v190, v191
 buffer_store_dwordx4 v[224:227], v9, s[48:51], s4 offen sc1
 v_perm_b32 v212, v153, v157, s62
 v_perm_b32 v213, v145, v149, s62
 v_perm_b32 v214, v157, v161, s62
 v_perm_b32 v215, v149, v153, s62
 v_perm_b32 v216, v153, v157, s63
 v_perm_b32 v217, v145, v149, s63
 v_perm_b32 v218, v157, v161, s63
 v_perm_b32 v219, v149, v153, s63
 v_dot2c_f32_bf16_dpp v192, v165, v213 quad_perm:[1,1,1,1] row_mask:0xf bank_mask:0xf
 v_dot2c_f32_bf16_dpp v194, v165, v215 quad_perm:[1,1,1,1] row_mask:0xf bank_mask:0xf
 v_dot2c_f32_bf16_dpp v193, v167, v217 quad_perm:[1,1,1,1] row_mask:0xf bank_mask:0xf
 v_dot2c_f32_bf16_dpp v195, v167, v219 quad_perm:[1,1,1,1] row_mask:0xf bank_mask:0xf
 v_dot2c_f32_bf16_dpp v192, v164, v212 quad_perm:[1,1,1,1] row_mask:0xf bank_mask:0xf
 v_dot2c_f32_bf16_dpp v194, v164, v214 quad_perm:[1,1,1,1] row_mask:0xf bank_mask:0xf
 v_dot2c_f32_bf16_dpp v193, v166, v216 quad_perm:[1,1,1,1] row_mask:0xf bank_mask:0xf
 v_dot2c_f32_bf16_dpp v195, v166, v218 quad_perm:[1,1,1,1] row_mask:0xf bank_mask:0xf
 v_lshlrev_b32 v212, 16, v181
 v_and_b32 v213, s64, v181
 v_lshlrev_b32 v214, 16, v185
 v_and_b32 v215, s64, v185
 v_pk_mul_f32 v[192:193], v[192:193], v[212:213]
 v_pk_mul_f32 v[194:195], v[194:195], v[214:215]
 v_cvt_pk_bf16_f32 v228, v192, v193
 v_cvt_pk_bf16_f32 v230, v194, v195
 buffer_store_dwordx4 v[228:231], v9, s[48:51], s5 offen sc1
 v_perm_b32 v204, v154, v158, s62
 v_perm_b32 v205, v146, v150, s62
 v_perm_b32 v206, v158, v162, s62
 v_perm_b32 v207, v150, v154, s62
 v_perm_b32 v208, v154, v158, s63
 v_perm_b32 v209, v146, v150, s63
 v_perm_b32 v210, v158, v162, s63
 v_perm_b32 v211, v150, v154, s63
 v_dot2c_f32_bf16_dpp v196, v165, v205 quad_perm:[2,2,2,2] row_mask:0xf bank_mask:0xf
 v_dot2c_f32_bf16_dpp v198, v165, v207 quad_perm:[2,2,2,2] row_mask:0xf bank_mask:0xf
 v_dot2c_f32_bf16_dpp v197, v167, v209 quad_perm:[2,2,2,2] row_mask:0xf bank_mask:0xf
 v_dot2c_f32_bf16_dpp v199, v167, v211 quad_perm:[2,2,2,2] row_mask:0xf bank_mask:0xf
 v_dot2c_f32_bf16_dpp v196, v164, v204 quad_perm:[2,2,2,2] row_mask:0xf bank_mask:0xf
 v_dot2c_f32_bf16_dpp v198, v164, v206 quad_perm:[2,2,2,2] row_mask:0xf bank_mask:0xf
 v_dot2c_f32_bf16_dpp v197, v166, v208 quad_perm:[2,2,2,2] row_mask:0xf bank_mask:0xf
 v_dot2c_f32_bf16_dpp v199, v166, v210 quad_perm:[2,2,2,2] row_mask:0xf bank_mask:0xf
 v_lshlrev_b32 v204, 16, v182
 v_and_b32 v205, s64, v182
 v_lshlrev_b32 v206, 16, v186
 v_and_b32 v207, s64, v186
 v_pk_mul_f32 v[196:197], v[196:197], v[204:205]
 v_pk_mul_f32 v[198:199], v[198:199], v[206:207]
 v_cvt_pk_bf16_f32 v232, v196, v197
 v_cvt_pk_bf16_f32 v234, v198, v199
 buffer_store_dwordx4 v[232:235], v9, s[48:51], s6 offen sc1
 v_perm_b32 v212, v155, v159, s62
 v_perm_b32 v213, v147, v151, s62
 v_perm_b32 v214, v159, v163, s62
 v_perm_b32 v215, v151, v155, s62
 v_perm_b32 v216, v155, v159, s63
 v_perm_b32 v217, v147, v151, s63
 v_perm_b32 v218, v159, v163, s63
 v_perm_b32 v219, v151, v155, s63
 v_dot2c_f32_bf16_dpp v200, v165, v213 quad_perm:[3,3,3,3] row_mask:0xf bank_mask:0xf
 v_dot2c_f32_bf16_dpp v202, v165, v215 quad_perm:[3,3,3,3] row_mask:0xf bank_mask:0xf
 v_dot2c_f32_bf16_dpp v201, v167, v217 quad_perm:[3,3,3,3] row_mask:0xf bank_mask:0xf
 v_dot2c_f32_bf16_dpp v203, v167, v219 quad_perm:[3,3,3,3] row_mask:0xf bank_mask:0xf
 v_dot2c_f32_bf16_dpp v200, v164, v212 quad_perm:[3,3,3,3] row_mask:0xf bank_mask:0xf
 v_dot2c_f32_bf16_dpp v202, v164, v214 quad_perm:[3,3,3,3] row_mask:0xf bank_mask:0xf
 v_dot2c_f32_bf16_dpp v201, v166, v216 quad_perm:[3,3,3,3] row_mask:0xf bank_mask:0xf
 v_dot2c_f32_bf16_dpp v203, v166, v218 quad_perm:[3,3,3,3] row_mask:0xf bank_mask:0xf
 v_lshlrev_b32 v212, 16, v183
 v_and_b32 v213, s64, v183
 v_lshlrev_b32 v214, 16, v187
 v_and_b32 v215, s64, v187
 v_pk_mul_f32 v[200:201], v[200:201], v[212:213]
 v_pk_mul_f32 v[202:203], v[202:203], v[214:215]
 v_cvt_pk_bf16_f32 v236, v200, v201
 v_cvt_pk_bf16_f32 v238, v202, v203
 buffer_store_dwordx4 v[236:239], v9, s[48:51], s7 offen sc1
 v_and_b32 v4, 15, v0
 v_add_u32 v4, 1, v4
 v_bfe_u32 v15, v4, 1, 1
 v_mul_u32_u24 v15, 4160, v15
 v_lshrrev_b32 v4, 2, v4
 v_lshl_add_u32 v15, v4, 3, v15
 v_bfe_u32 v4, v0, 4, 3
 v_lshl_add_u32 v15, v4, 6, v15
 s_lshr_b32 s3, s56, 1
 s_mul_i32 s3, s3, 8320
 s_add_u32 s3, s3, 140288
 v_add_u32 v15, s3, v15
 v_and_b32 v12, 1, v0
 v_mul_u32_u24 v12, 0x020202, v12
 v_lshl_or_b32 v12, v12, 8, v12
 v_sub_u32 v12, 0x05040302, v12
 s_bfe_u32 s79, s2, 0x20003
 s_lshr_b32 s67, s2, 5
 s_and_b32 s3, s2, 1
 s_lshl_b32 s3, s3, 2
 s_add_u32 s59, s3, s79
 s_bfe_u32 s3, s2, 0x20001
 s_mul_i32 s3, s3, 7
 s_add_u32 s60, s3, s67
 s_mov_b32 s78, s67
 s_cmp_ge_u32 s67, 7
 s_cselect_b32 s34, 0, 1835008
 s_mov_b32 s35, 0x20000
 s_mov_b32 s38, s34
 s_mov_b32 s39, 0x20000
 v_bfe_u32 v169, v0, 3, 3
 v_and_b32 v171, 7, v0
 v_mul_u32_u24 v170, 3584, v169
 v_and_b32 v172, 2, v169
 v_bfe_u32 v173, v0, 6, 1
 v_lshl_or_b32 v172, v173, 2, v172
 v_xor_b32 v173, v171, v172
 s_lshl_b32 s3, s60, 7
 v_add_u32 v170, s3, v170
 v_lshl_add_u32 v252, v173, 4, v170
 v_and_b32 v172, 6, v169
 v_xor_b32 v171, v171, v172
 v_lshlrev_b32 v169, 10, v169
 v_lshl_add_u32 v254, v171, 4, v169
 v_mov_b32 v176, 0
 v_and_b32 v13, 127, v0
 v_lshlrev_b32 v13, 2, v13
 v_lshrrev_b32 v14, 7, v0
 v_mul_u32_u24 v14, 4608, v14
 s_mov_b32 s3, 135168
 v_add3_u32 v13, v13, v14, s3
 ds_write_b32 v13, v176
 v_and_b32 v13, 15, v0
 v_lshlrev_b32 v13, 5, v13
 v_bfe_u32 v14, v0, 4, 3
 v_lshlrev_b32 v14, 6, v14
 v_sub_u32 v14, v14, v13
 v_add_u32 v14, 480, v14
 s_lshr_b32 s3, s56, 1
 s_mul_i32 s3, s3, 4608
 s_add_u32 s3, s3, 131072
 v_add_u32 v13, 0, v14
 v_lshrrev_b32 v177, 4, v13
 v_and_b32 v177, 16, v177
 v_xor_b32 v13, v13, v177
 v_add_u32 v8, s3, v13
 v_add_u32 v13, 16, v14
 v_lshrrev_b32 v177, 4, v13
 v_and_b32 v177, 16, v177
 v_xor_b32 v13, v13, v177
 v_add_u32 v10, s3, v13
 v_add_u32 v13, 32, v14
 v_lshrrev_b32 v177, 4, v13
 v_and_b32 v177, 16, v177
 v_xor_b32 v13, v13, v177
 v_add_u32 v248, s3, v13
 v_add_u32 v13, 48, v14
 v_lshrrev_b32 v177, 4, v13
 v_and_b32 v177, 16, v177
 v_xor_b32 v13, v13, v177
 v_add_u32 v249, s3, v13
 v_lshlrev_b32 v13, 2, v0
 v_sub_u32 v13, 1020, v13
 v_lshrrev_b32 v177, 4, v13
 v_and_b32 v177, 16, v177
 v_xor_b32 v13, v13, v177
 v_add_u32 v13, 131072, v13
 v_mul_u32_u24 v14, 16640, v2
 v_lshl_add_u32 v14, v1, 4, v14
 s_and_b32 s4, s96, 3
 s_lshl_b32 s4, s4, 12
 s_lshr_b32 s3, s96, 2
 s_lshl_b32 s3, s3, 6
 s_add_u32 s4, s4, s3
 s_add_u32 s4, s4, 1048576
 s_add_u32 s5, s4, 1064960
 s_add_u32 s6, s4, 2129920
 s_add_u32 s7, s4, 3194880
 s_lshl_b32 s100, s79, 4
 s_and_b32 s3, s2, 1
 s_lshl_b32 s3, s3, 3
 s_add_u32 s100, s100, s3
 s_add_u32 s100, s100, s56
 s_lshl_b32 s3, s78, 3
 s_sub_u32 s53, s100, s3
 s_lshl_b32 s53, s53, 11
 s_add_u32 s3, s100, 0
 s_and_b32 s3, s3, 63
 s_mul_i32 s12, s3, 28672
 s_add_u32 s3, s100, 4
 s_and_b32 s3, s3, 63
 s_mul_i32 s13, s3, 28672
 s_add_u32 s3, s100, 8
 s_and_b32 s3, s3, 63
 s_mul_i32 s14, s3, 28672
 s_add_u32 s3, s100, 12
 s_and_b32 s3, s3, 63
 s_mul_i32 s15, s3, 28672
 s_add_u32 s3, s100, 16
 s_and_b32 s3, s3, 63
 s_mul_i32 s16, s3, 28672
 s_add_u32 s3, s100, 20
 s_and_b32 s3, s3, 63
 s_mul_i32 s17, s3, 28672
 s_add_u32 s3, s100, 24
 s_and_b32 s3, s3, 63
 s_mul_i32 s18, s3, 28672
 s_add_u32 s3, s100, 28
 s_and_b32 s3, s3, 63
 s_mul_i32 s19, s3, 28672
 s_add_u32 s3, s100, 32
 s_and_b32 s3, s3, 63
 s_mul_i32 s20, s3, 28672
 s_add_u32 s3, s100, 36
 s_and_b32 s3, s3, 63
 s_mul_i32 s21, s3, 28672
 s_add_u32 s3, s100, 40
 s_and_b32 s3, s3, 63
 s_mul_i32 s22, s3, 28672
 s_add_u32 s3, s100, 44
 s_and_b32 s3, s3, 63
 s_mul_i32 s23, s3, 28672
 s_add_u32 s3, s100, 48
 s_and_b32 s3, s3, 63
 s_mul_i32 s24, s3, 28672
 s_add_u32 s3, s100, 52
 s_and_b32 s3, s3, 63
 s_mul_i32 s25, s3, 28672
 s_add_u32 s3, s100, 56
 s_and_b32 s3, s3, 63
 s_mul_i32 s26, s3, 28672
 s_add_u32 s3, s100, 60
 s_and_b32 s3, s3, 63
 s_mul_i32 s27, s3, 28672
 s_and_b32 s3, s2, 7
 s_lshl_b32 s3, s3, 2
 s_add_u32 s72, s3, s79
 s_lshl_b32 s74, s67, 7
 s_lshl_b32 s3, s79, 1
 s_add_u32 s3, s3, s67
 s_mul_i32 s55, s56, 8192
 s_add_u32 s55, s55, 131072
 s_mul_i32 s100, s56, 458752
 s_add_u32 s100, s100, s74
 s_cmp_ge_u32 s3, 7
 s_cselect_b32 s66, 7, 0
 s_sub_u32 s3, s3, s66
 s_lshl_b32 s66, s3, 16
 s_add_u32 s80, s66, s100
 s_add_u32 s3, s3, 1
 s_cmp_ge_u32 s3, 7
 s_cselect_b32 s66, 7, 0
 s_sub_u32 s3, s3, s66
 s_lshl_b32 s66, s3, 16
 s_add_u32 s81, s66, s100
 s_add_u32 s3, s3, 1
 s_cmp_ge_u32 s3, 7
 s_cselect_b32 s66, 7, 0
 s_sub_u32 s3, s3, s66
 s_lshl_b32 s66, s3, 16
 s_add_u32 s82, s66, s100
 s_add_u32 s3, s3, 1
 s_cmp_ge_u32 s3, 7
 s_cselect_b32 s66, 7, 0
 s_sub_u32 s3, s3, s66
 s_lshl_b32 s66, s3, 16
 s_add_u32 s83, s66, s100
 s_add_u32 s3, s3, 1
 s_cmp_ge_u32 s3, 7
 s_cselect_b32 s66, 7, 0
 s_sub_u32 s3, s3, s66
 s_lshl_b32 s66, s3, 16
 s_add_u32 s84, s66, s100
 s_add_u32 s3, s3, 1
 s_cmp_ge_u32 s3, 7
 s_cselect_b32 s66, 7, 0
 s_sub_u32 s3, s3, s66
 s_lshl_b32 s66, s3, 16
 s_add_u32 s85, s66, s100
 s_add_u32 s3, s3, 1
 s_cmp_ge_u32 s3, 7
 s_cselect_b32 s66, 7, 0
 s_sub_u32 s3, s3, s66
 s_lshl_b32 s66, s3, 16
 s_add_u32 s86, s66, s100
 s_add_u32 s3, s3, 1
 s_add_u32 s101, s53, 0
 s_and_b32 m0, s101, 0x1ffff
 s_nop 0
 buffer_load_dwordx4 v252, s[32:35], s12 offen  lds
 s_add_u32 m0, m0, 1024
 s_nop 0
 buffer_load_dwordx4 v252, s[36:39], s12 offen  lds
 s_waitcnt vmcnt(9)
 s_barrier
 v_mov_b32 v216, v12
 v_add_u32 v12, 2048, v15
 ds_read2_b64 v[16:19], v15 offset0:0 offset1:1
 ds_read2_b64 v[20:23], v15 offset0:2 offset1:3
 ds_read2_b64 v[24:27], v15 offset0:4 offset1:5
 ds_read2_b64 v[28:31], v15 offset0:6 offset1:7
 ds_read_b32 v208, v15 offset:64
 ds_read2_b64 v[32:35], v15 offset0:64 offset1:65
 ds_read2_b64 v[36:39], v15 offset0:66 offset1:67
 ds_read2_b64 v[40:43], v15 offset0:68 offset1:69
 ds_read2_b64 v[44:47], v15 offset0:70 offset1:71
 ds_read_b32 v209, v15 offset:576
 ds_read2_b64 v[48:51], v15 offset0:128 offset1:129
 ds_read2_b64 v[52:55], v15 offset0:130 offset1:131
 ds_read2_b64 v[56:59], v15 offset0:132 offset1:133
 ds_read2_b64 v[60:63], v15 offset0:134 offset1:135
 ds_read_b32 v210, v15 offset:1088
 s_waitcnt lgkmcnt(10)
 v_perm_b32 v16, v17, v16, v216
 v_perm_b32 v17, v18, v17, v216
 v_perm_b32 v18, v19, v18, v216
 v_perm_b32 v19, v20, v19, v216
 v_perm_b32 v20, v21, v20, v216
 v_perm_b32 v21, v22, v21, v216
 v_perm_b32 v22, v23, v22, v216
 v_perm_b32 v23, v24, v23, v216
 v_perm_b32 v24, v25, v24, v216
 v_perm_b32 v25, v26, v25, v216
 v_perm_b32 v26, v27, v26, v216
 v_perm_b32 v27, v28, v27, v216
 v_perm_b32 v28, v29, v28, v216
 v_perm_b32 v29, v30, v29, v216
 v_perm_b32 v30, v31, v30, v216
 v_perm_b32 v31, v208, v31, v216
 ds_read2_b64 v[64:67], v15 offset0:192 offset1:193
 ds_read2_b64 v[68:71], v15 offset0:194 offset1:195
 ds_read2_b64 v[72:75], v15 offset0:196 offset1:197
 ds_read2_b64 v[76:79], v15 offset0:198 offset1:199
 ds_read_b32 v211, v15 offset:1600
 s_waitcnt lgkmcnt(10)
 v_perm_b32 v32, v33, v32, v216
 v_perm_b32 v33, v34, v33, v216
 v_perm_b32 v34, v35, v34, v216
 v_perm_b32 v35, v36, v35, v216
 v_perm_b32 v36, v37, v36, v216
 v_perm_b32 v37, v38, v37, v216
 v_perm_b32 v38, v39, v38, v216
 v_perm_b32 v39, v40, v39, v216
 v_perm_b32 v40, v41, v40, v216
 v_perm_b32 v41, v42, v41, v216
 v_perm_b32 v42, v43, v42, v216
 v_perm_b32 v43, v44, v43, v216
 v_perm_b32 v44, v45, v44, v216
 v_perm_b32 v45, v46, v45, v216
 v_perm_b32 v46, v47, v46, v216
 v_perm_b32 v47, v209, v47, v216
 ds_read2_b64 v[80:83], v12 offset0:0 offset1:1
 ds_read2_b64 v[84:87], v12 offset0:2 offset1:3
 ds_read2_b64 v[88:91], v12 offset0:4 offset1:5
 ds_read2_b64 v[92:95], v12 offset0:6 offset1:7
 ds_read_b32 v212, v15 offset:2112
 s_waitcnt lgkmcnt(10)
 v_perm_b32 v48, v49, v48, v216
 v_perm_b32 v49, v50, v49, v216
 v_perm_b32 v50, v51, v50, v216
 v_perm_b32 v51, v52, v51, v216
 v_perm_b32 v52, v53, v52, v216
 v_perm_b32 v53, v54, v53, v216
 v_perm_b32 v54, v55, v54, v216
 v_perm_b32 v55, v56, v55, v216
 v_perm_b32 v56, v57, v56, v216
 v_perm_b32 v57, v58, v57, v216
 v_perm_b32 v58, v59, v58, v216
 v_perm_b32 v59, v60, v59, v216
 v_perm_b32 v60, v61, v60, v216
 v_perm_b32 v61, v62, v61, v216
 v_perm_b32 v62, v63, v62, v216
 v_perm_b32 v63, v210, v63, v216
 ds_read2_b64 v[96:99], v12 offset0:64 offset1:65
 ds_read2_b64 v[100:103], v12 offset0:66 offset1:67
 ds_read2_b64 v[104:107], v12 offset0:68 offset1:69
 ds_read2_b64 v[108:111], v12 offset0:70 offset1:71
 ds_read_b32 v213, v15 offset:2624
 s_waitcnt lgkmcnt(10)
 v_perm_b32 v64, v65, v64, v216
 v_perm_b32 v65, v66, v65, v216
 v_perm_b32 v66, v67, v66, v216
 v_perm_b32 v67, v68, v67, v216
 v_perm_b32 v68, v69, v68, v216
 v_perm_b32 v69, v70, v69, v216
 v_perm_b32 v70, v71, v70, v216
 v_perm_b32 v71, v72, v71, v216
 v_perm_b32 v72, v73, v72, v216
 v_perm_b32 v73, v74, v73, v216
 v_perm_b32 v74, v75, v74, v216
 v_perm_b32 v75, v76, v75, v216
 v_perm_b32 v76, v77, v76, v216
 v_perm_b32 v77, v78, v77, v216
 v_perm_b32 v78, v79, v78, v216
 v_perm_b32 v79, v211, v79, v216
 ds_read2_b64 v[112:115], v12 offset0:128 offset1:129
 ds_read2_b64 v[116:119], v12 offset0:130 offset1:131
 ds_read2_b64 v[120:123], v12 offset0:132 offset1:133
 ds_read2_b64 v[124:127], v12 offset0:134 offset1:135
 ds_read_b32 v214, v15 offset:3136
 s_waitcnt lgkmcnt(10)
 v_perm_b32 v80, v81, v80, v216
 v_perm_b32 v81, v82, v81, v216
 v_perm_b32 v82, v83, v82, v216
 v_perm_b32 v83, v84, v83, v216
 v_perm_b32 v84, v85, v84, v216
 buffer_load_dwordx4 v[160:163], v14, s[48:51], s4 offen sc1
 buffer_load_dwordx4 v[164:167], v14, s[48:51], s5 offen sc1
 buffer_load_dwordx4 v[168:171], v14, s[48:51], s6 offen sc1
 buffer_load_dwordx4 v[172:175], v14, s[48:51], s7 offen sc1
 s_barrier
 s_add_u32 s101, s53, 8192
 s_and_b32 m0, s101, 0x1ffff
 s_nop 0
 buffer_load_dwordx4 v252, s[32:35], s13 offen  lds
 s_add_u32 m0, m0, 1024
 s_nop 0
 buffer_load_dwordx4 v252, s[36:39], s13 offen  lds
 s_add_u32 s101, s53, 16384
 s_and_b32 m0, s101, 0x1ffff
 s_nop 0
 buffer_load_dwordx4 v252, s[32:35], s14 offen  lds
 s_add_u32 s101, s53, 24576
 s_and_b32 m0, s101, 0x1ffff
 s_nop 0
 buffer_load_dwordx4 v252, s[32:35], s15 offen  lds
 v_perm_b32 v85, v86, v85, v216
 v_perm_b32 v86, v87, v86, v216
 v_perm_b32 v87, v88, v87, v216
 v_perm_b32 v88, v89, v88, v216
 v_perm_b32 v89, v90, v89, v216
 v_perm_b32 v90, v91, v90, v216
 v_perm_b32 v91, v92, v91, v216
 v_perm_b32 v92, v93, v92, v216
 v_perm_b32 v93, v94, v93, v216
 v_perm_b32 v94, v95, v94, v216
 v_perm_b32 v95, v212, v95, v216
 ds_read2_b64 v[128:131], v12 offset0:192 offset1:193
 ds_read2_b64 v[132:135], v12 offset0:194 offset1:195
 ds_read2_b64 v[136:139], v12 offset0:196 offset1:197
 ds_read2_b64 v[140:143], v12 offset0:198 offset1:199
 ds_read_b32 v215, v15 offset:3648
 s_waitcnt lgkmcnt(10)
 v_perm_b32 v96, v97, v96, v216
 v_perm_b32 v97, v98, v97, v216
 v_perm_b32 v98, v99, v98, v216
 v_perm_b32 v99, v100, v99, v216
 v_perm_b32 v100, v101, v100, v216
 v_perm_b32 v101, v102, v101, v216
 v_perm_b32 v102, v103, v102, v216
 v_perm_b32 v103, v104, v103, v216
 v_perm_b32 v104, v105, v104, v216
 v_perm_b32 v105, v106, v105, v216
 v_perm_b32 v106, v107, v106, v216
 v_perm_b32 v107, v108, v107, v216
 v_perm_b32 v108, v109, v108, v216
 v_perm_b32 v109, v110, v109, v216
 v_perm_b32 v110, v111, v110, v216
 v_perm_b32 v111, v213, v111, v216
 s_waitcnt lgkmcnt(5)
 v_perm_b32 v112, v113, v112, v216
 v_perm_b32 v113, v114, v113, v216
 v_perm_b32 v114, v115, v114, v216
 v_perm_b32 v115, v116, v115, v216
 v_perm_b32 v116, v117, v116, v216
 v_perm_b32 v117, v118, v117, v216
 v_perm_b32 v118, v119, v118, v216
 v_perm_b32 v119, v120, v119, v216
 v_perm_b32 v120, v121, v120, v216
 v_perm_b32 v121, v122, v121, v216
 v_perm_b32 v122, v123, v122, v216
 v_perm_b32 v123, v124, v123, v216
 v_perm_b32 v124, v125, v124, v216
 v_perm_b32 v125, v126, v125, v216
 v_perm_b32 v126, v127, v126, v216
 v_perm_b32 v127, v214, v127, v216
 s_waitcnt lgkmcnt(0)
 v_perm_b32 v128, v129, v128, v216
 v_perm_b32 v129, v130, v129, v216
 v_perm_b32 v130, v131, v130, v216
 v_perm_b32 v131, v132, v131, v216
 v_perm_b32 v132, v133, v132, v216
 v_perm_b32 v133, v134, v133, v216
 v_perm_b32 v134, v135, v134, v216
 v_perm_b32 v135, v136, v135, v216
 v_perm_b32 v136, v137, v136, v216
 v_perm_b32 v137, v138, v137, v216
 v_perm_b32 v138, v139, v138, v216
 v_perm_b32 v139, v140, v139, v216
 v_perm_b32 v140, v141, v140, v216
 v_perm_b32 v141, v142, v141, v216
 v_perm_b32 v142, v143, v142, v216
 v_perm_b32 v143, v215, v143, v216
 s_waitcnt vmcnt(7)
L_h1:
 v_xor_b32 v4, s61, v161
 v_bitop3_b32 v4, v4, v163, s61 bitop3:0xf6
 v_perm_b32 v176, v160, v162, s62
 v_perm_b32 v177, v160, v162, s63
 ds_write2st64_b32 v13, v176, v177 offset0:12 offset1:30
 s_waitcnt vmcnt(6)
 v_bitop3_b32 v4, v4, v165, s61 bitop3:0xf6
 v_bitop3_b32 v4, v4, v167, s61 bitop3:0xf6
 v_perm_b32 v178, v164, v166, s62
 v_perm_b32 v179, v164, v166, s63
 ds_write2st64_b32 v13, v178, v179 offset0:8 offset1:26
 s_waitcnt vmcnt(5)
 v_bitop3_b32 v4, v4, v169, s61 bitop3:0xf6
 v_bitop3_b32 v4, v4, v171, s61 bitop3:0xf6
 v_perm_b32 v180, v168, v170, s62
 v_perm_b32 v181, v168, v170, s63
 ds_write2st64_b32 v13, v180, v181 offset0:4 offset1:22
 s_waitcnt vmcnt(4)
 v_bitop3_b32 v4, v4, v173, s61 bitop3:0xf6
 v_bitop3_b32 v4, v4, v175, s61 bitop3:0xf6
 v_cmp_ne_u32 vcc, 0, v4
 v_perm_b32 v182, v172, v174, s62
 v_perm_b32 v183, v172, v174, s63
 ds_write2st64_b32 v13, v182, v183 offset0:0 offset1:18
 s_mov_b64 exec, -1
 s_waitcnt lgkmcnt(0)
 s_cbranch_vccnz L_h1_r
L_h1_ok:
 s_barrier
 ds_read_b128 v[144:147], v8 offset:3584
 ds_read_b128 v[148:151], v8 offset:3072
 ds_read_b128 v[152:155], v8 offset:2560
 ds_read_b128 v[156:159], v8 offset:2048
 ds_read_b128 v[160:163], v8 offset:1536
 ds_read_b128 v[164:167], v8 offset:1024
 ds_read_b128 v[168:171], v8 offset:512
 ds_read_b128 v[172:175], v8 offset:0
 s_waitcnt lgkmcnt(7)
 v_mfma_f32_16x16x32_bf16 a[224:227], v[16:19], v[144:147], 0
 s_add_u32 s101, s53, 16384
 s_and_b32 m0, s101, 0x1ffff
 v_mfma_f32_16x16x32_bf16 a[228:231], v[32:35], v[144:147], 0
 s_add_u32 m0, m0, 1024
 s_nop 0
 buffer_load_dwordx4 v252, s[36:39], s14 offen  lds
 v_mfma_f32_16x16x32_bf16 a[232:235], v[48:51], v[144:147], 0
 s_add_u32 s101, s53, 24576
 s_and_b32 m0, s101, 0x1ffff
 v_mfma_f32_16x16x32_bf16 a[236:239], v[64:67], v[144:147], 0
 s_add_u32 m0, m0, 1024
 s_nop 0
 buffer_load_dwordx4 v252, s[36:39], s15 offen  lds
 v_mfma_f32_16x16x32_bf16 a[240:243], v[80:83], v[144:147], 0
 v_bfe_u32 v13, v0, 4, 2
 v_lshlrev_b32 v14, 6, v13
 v_mfma_f32_16x16x32_bf16 a[244:247], v[96:99], v[144:147], 0
 v_xor_b32 v13, v14, v6
 s_lshl_b32 s3, s56, 13
 v_mfma_f32_16x16x32_bf16 a[248:251], v[112:115], v[144:147], 0
 s_add_u32 s3, s3, 131072
 v_add_u32 v13, s3, v13
 v_mfma_f32_16x16x32_bf16 a[252:255], v[128:131], v[144:147], 0
 v_bfe_u32 v15, v0, 1, 2
 s_waitcnt lgkmcnt(0)
 v_mfma_f32_16x16x32_bf16 a[228:231], v[16:19], v[148:151], a[228:231]
 ds_read_b128 v[176:179], v10 offset:3584
 ds_read_b128 v[180:183], v10 offset:3072
 v_mfma_f32_16x16x32_bf16 a[232:235], v[16:19], v[152:155], a[232:235]
 ds_read_b128 v[184:187], v10 offset:2560
 ds_read_b128 v[188:191], v10 offset:2048
 v_mfma_f32_16x16x32_bf16 a[232:235], v[32:35], v[148:151], a[232:235]
 ds_read_b128 v[192:195], v10 offset:1536
 ds_read_b128 v[196:199], v10 offset:1024
 v_mfma_f32_16x16x32_bf16 a[236:239], v[16:19], v[156:159], a[236:239]
 ds_read_b128 v[200:203], v10 offset:512
 ds_read_b128 v[204:207], v10 offset:0
 v_mfma_f32_16x16x32_bf16 a[236:239], v[32:35], v[152:155], a[236:239]
 v_bfe_u32 v14, v0, 3, 4
 v_lshlrev_b32 v12, 2, v15
 v_mfma_f32_16x16x32_bf16 a[236:239], v[48:51], v[148:151], a[236:239]
 v_xor_b32 v14, v14, v12
 v_lshlrev_b32 v14, 4, v14
 v_mfma_f32_16x16x32_bf16 a[240:243], v[16:19], v[160:163], a[240:243]
 v_lshl_add_u32 v14, v15, 8, v14
 v_lshrrev_b32 v15, 7, v0
 v_mfma_f32_16x16x32_bf16 a[240:243], v[32:35], v[156:159], a[240:243]
 v_lshl_add_u32 v14, v15, 10, v14
 v_and_b32 v15, 1, v0
 v_mfma_f32_16x16x32_bf16 a[240:243], v[48:51], v[152:155], a[240:243]
 v_lshl_add_u32 v14, v15, 3, v14
 v_add_u32 v14, 131072, v14
 v_mfma_f32_16x16x32_bf16 a[240:243], v[64:67], v[148:151], a[240:243]
 s_mul_i32 s4, s96, 16640
 s_add_u32 s4, s4, 5373952
 v_mfma_f32_16x16x32_bf16 a[244:247], v[16:19], v[164:167], a[244:247]
 s_add_u32 s5, s4, 4096
 s_add_u32 s6, s4, 8192
 v_mfma_f32_16x16x32_bf16 a[244:247], v[32:35], v[160:163], a[244:247]
 s_add_u32 s7, s4, 12288
 v_mfma_f32_16x16x32_bf16 a[244:247], v[48:51], v[156:159], a[244:247]
 v_mfma_f32_16x16x32_bf16 a[244:247], v[64:67], v[152:155], a[244:247]
 v_mfma_f32_16x16x32_bf16 a[244:247], v[80:83], v[148:151], a[244:247]
 v_mfma_f32_16x16x32_bf16 a[248:251], v[16:19], v[168:171], a[248:251]
 v_mfma_f32_16x16x32_bf16 a[248:251], v[32:35], v[164:167], a[248:251]
 buffer_load_dwordx4 a[0:3], v254, s[40:43], s80 offen
 v_mfma_f32_16x16x32_bf16 a[248:251], v[48:51], v[160:163], a[248:251]
 v_mfma_f32_16x16x32_bf16 a[248:251], v[64:67], v[156:159], a[248:251]
 v_mfma_f32_16x16x32_bf16 a[248:251], v[80:83], v[152:155], a[248:251]
 v_mfma_f32_16x16x32_bf16 a[248:251], v[96:99], v[148:151], a[248:251]
 v_mfma_f32_16x16x32_bf16 a[252:255], v[16:19], v[172:175], a[252:255]
 s_add_u32 s100, s80, 8192
 v_mfma_f32_16x16x32_bf16 a[252:255], v[32:35], v[168:171], a[252:255]
 v_mfma_f32_16x16x32_bf16 a[252:255], v[48:51], v[164:167], a[252:255]
 v_mfma_f32_16x16x32_bf16 a[252:255], v[64:67], v[160:163], a[252:255]
 v_mfma_f32_16x16x32_bf16 a[252:255], v[80:83], v[156:159], a[252:255]
 v_mfma_f32_16x16x32_bf16 a[252:255], v[96:99], v[152:155], a[252:255]
 buffer_load_dwordx4 a[4:7], v254, s[40:43], s100 offen
 v_mfma_f32_16x16x32_bf16 a[252:255], v[112:115], v[148:151], a[252:255]
 s_waitcnt lgkmcnt(0)
 v_mfma_f32_16x16x32_bf16 a[252:255], v[20:23], v[204:207], a[252:255]
 v_mfma_f32_16x16x32_bf16 a[252:255], v[36:39], v[200:203], a[252:255]
 v_mfma_f32_16x16x32_bf16 a[252:255], v[52:55], v[196:199], a[252:255]
 v_mfma_f32_16x16x32_bf16 a[252:255], v[68:71], v[192:195], a[252:255]
 s_add_u32 s100, s80, 16384
 v_mfma_f32_16x16x32_bf16 a[252:255], v[84:87], v[188:191], a[252:255]
 v_mfma_f32_16x16x32_bf16 a[252:255], v[100:103], v[184:187], a[252:255]
 v_mfma_f32_16x16x32_bf16 a[252:255], v[116:119], v[180:183], a[252:255]
 v_mfma_f32_16x16x32_bf16 a[252:255], v[132:135], v[176:179], a[252:255]
 v_mfma_f32_16x16x32_bf16 a[248:251], v[20:23], v[200:203], a[248:251]
 ds_read_b128 v[144:147], v248 offset:3584
 ds_read_b128 v[148:151], v248 offset:3072
 v_mfma_f32_16x16x32_bf16 a[248:251], v[36:39], v[196:199], a[248:251]
 ds_read_b128 v[152:155], v248 offset:2560
 ds_read_b128 v[156:159], v248 offset:2048
 v_mfma_f32_16x16x32_bf16 a[248:251], v[52:55], v[192:195], a[248:251]
 ds_read_b128 v[160:163], v248 offset:1536
 ds_read_b128 v[164:167], v248 offset:1024
 v_mfma_f32_16x16x32_bf16 a[248:251], v[68:71], v[188:191], a[248:251]
 ds_read_b128 v[168:171], v248 offset:512
 ds_read_b128 v[172:175], v248 offset:0
 v_mfma_f32_16x16x32_bf16 a[248:251], v[84:87], v[184:187], a[248:251]
 buffer_load_dwordx4 a[8:11], v254, s[40:43], s100 offen
 v_mfma_f32_16x16x32_bf16 a[248:251], v[100:103], v[180:183], a[248:251]
 s_add_u32 s100, s80, 24576
 v_mfma_f32_16x16x32_bf16 a[248:251], v[116:119], v[176:179], a[248:251]
 v_mfma_f32_16x16x32_bf16 a[244:247], v[20:23], v[196:199], a[244:247]
 v_mfma_f32_16x16x32_bf16 a[244:247], v[36:39], v[192:195], a[244:247]
 v_mfma_f32_16x16x32_bf16 a[244:247], v[52:55], v[188:191], a[244:247]
 v_mfma_f32_16x16x32_bf16 a[244:247], v[68:71], v[184:187], a[244:247]
 buffer_load_dwordx4 a[12:15], v254, s[40:43], s100 offen
 v_mfma_f32_16x16x32_bf16 a[244:247], v[84:87], v[180:183], a[244:247]
 v_mfma_f32_16x16x32_bf16 a[244:247], v[100:103], v[176:179], a[244:247]
 v_mfma_f32_16x16x32_bf16 a[240:243], v[20:23], v[192:195], a[240:243]
 v_mfma_f32_16x16x32_bf16 a[240:243], v[36:39], v[188:191], a[240:243]
 v_mfma_f32_16x16x32_bf16 a[240:243], v[52:55], v[184:187], a[240:243]
 s_add_u32 s100, s80, 32768
 v_mfma_f32_16x16x32_bf16 a[240:243], v[68:71], v[180:183], a[240:243]
 v_mfma_f32_16x16x32_bf16 a[240:243], v[84:87], v[176:179], a[240:243]
 v_mfma_f32_16x16x32_bf16 a[236:239], v[20:23], v[188:191], a[236:239]
 v_mfma_f32_16x16x32_bf16 a[236:239], v[36:39], v[184:187], a[236:239]
 v_mfma_f32_16x16x32_bf16 a[236:239], v[52:55], v[180:183], a[236:239]
 buffer_load_dwordx4 a[16:19], v254, s[40:43], s100 offen
 v_mfma_f32_16x16x32_bf16 a[236:239], v[68:71], v[176:179], a[236:239]
 v_mfma_f32_16x16x32_bf16 a[232:235], v[20:23], v[184:187], a[232:235]
 v_mfma_f32_16x16x32_bf16 a[232:235], v[36:39], v[180:183], a[232:235]
 v_mfma_f32_16x16x32_bf16 a[232:235], v[52:55], v[176:179], a[232:235]
 v_mfma_f32_16x16x32_bf16 a[228:231], v[20:23], v[180:183], a[228:231]
 s_add_u32 s100, s80, 40960
 v_mfma_f32_16x16x32_bf16 a[228:231], v[36:39], v[176:179], a[228:231]
 v_mfma_f32_16x16x32_bf16 a[224:227], v[20:23], v[176:179], a[224:227]
 s_waitcnt lgkmcnt(0)
 v_mfma_f32_16x16x32_bf16 a[224:227], v[24:27], v[144:147], a[224:227]
 v_mfma_f32_16x16x32_bf16 a[228:231], v[24:27], v[148:151], a[228:231]
 v_mfma_f32_16x16x32_bf16 a[228:231], v[40:43], v[144:147], a[228:231]
 buffer_load_dwordx4 a[20:23], v254, s[40:43], s100 offen
 v_mfma_f32_16x16x32_bf16 a[232:235], v[24:27], v[152:155], a[232:235]
 v_mfma_f32_16x16x32_bf16 a[232:235], v[40:43], v[148:151], a[232:235]
 v_mfma_f32_16x16x32_bf16 a[232:235], v[56:59], v[144:147], a[232:235]
 v_mfma_f32_16x16x32_bf16 a[236:239], v[24:27], v[156:159], a[236:239]
 v_mfma_f32_16x16x32_bf16 a[236:239], v[40:43], v[152:155], a[236:239]
 s_add_u32 s100, s80, 49152
 v_mfma_f32_16x16x32_bf16 a[236:239], v[56:59], v[148:151], a[236:239]
 ds_read_b128 v[176:179], v249 offset:3584
 ds_read_b128 v[180:183], v249 offset:3072
 v_mfma_f32_16x16x32_bf16 a[236:239], v[72:75], v[144:147], a[236:239]
 ds_read_b128 v[184:187], v249 offset:2560
 ds_read_b128 v[188:191], v249 offset:2048
 v_mfma_f32_16x16x32_bf16 a[240:243], v[24:27], v[160:163], a[240:243]
 ds_read_b128 v[192:195], v249 offset:1536
 ds_read_b128 v[196:199], v249 offset:1024
 v_mfma_f32_16x16x32_bf16 a[240:243], v[40:43], v[156:159], a[240:243]
 ds_read_b128 v[200:203], v249 offset:512
 ds_read_b128 v[204:207], v249 offset:0
 v_mfma_f32_16x16x32_bf16 a[240:243], v[56:59], v[152:155], a[240:243]
 buffer_load_dwordx4 a[24:27], v254, s[40:43], s100 offen
 v_mfma_f32_16x16x32_bf16 a[240:243], v[72:75], v[148:151], a[240:243]
 v_mfma_f32_16x16x32_bf16 a[240:243], v[88:91], v[144:147], a[240:243]
 v_mfma_f32_16x16x32_bf16 a[244:247], v[24:27], v[164:167], a[244:247]
 v_mfma_f32_16x16x32_bf16 a[244:247], v[40:43], v[160:163], a[244:247]
 v_mfma_f32_16x16x32_bf16 a[244:247], v[56:59], v[156:159], a[244:247]
 s_add_u32 s100, s80, 57344
 v_mfma_f32_16x16x32_bf16 a[244:247], v[72:75], v[152:155], a[244:247]
 v_mfma_f32_16x16x32_bf16 a[244:247], v[88:91], v[148:151], a[244:247]
 v_mfma_f32_16x16x32_bf16 a[244:247], v[104:107], v[144:147], a[244:247]
 v_mfma_f32_16x16x32_bf16 a[248:251], v[24:27], v[168:171], a[248:251]
 v_mfma_f32_16x16x32_bf16 a[248:251], v[40:43], v[164:167], a[248:251]
 buffer_load_dwordx4 a[28:31], v254, s[40:43], s100 offen
 v_mfma_f32_16x16x32_bf16 a[248:251], v[56:59], v[160:163], a[248:251]
 v_mfma_f32_16x16x32_bf16 a[248:251], v[72:75], v[156:159], a[248:251]
 v_mfma_f32_16x16x32_bf16 a[248:251], v[88:91], v[152:155], a[248:251]
 v_mfma_f32_16x16x32_bf16 a[248:251], v[104:107], v[148:151], a[248:251]
 v_mfma_f32_16x16x32_bf16 a[248:251], v[120:123], v[144:147], a[248:251]
 v_mfma_f32_16x16x32_bf16 a[252:255], v[24:27], v[172:175], a[252:255]
 v_mfma_f32_16x16x32_bf16 a[252:255], v[40:43], v[168:171], a[252:255]
 v_mfma_f32_16x16x32_bf16 a[252:255], v[56:59], v[164:167], a[252:255]
 v_mfma_f32_16x16x32_bf16 a[252:255], v[72:75], v[160:163], a[252:255]
 v_mfma_f32_16x16x32_bf16 a[252:255], v[88:91], v[156:159], a[252:255]
 v_mfma_f32_16x16x32_bf16 a[252:255], v[104:107], v[152:155], a[252:255]
 v_mfma_f32_16x16x32_bf16 a[252:255], v[120:123], v[148:151], a[252:255]
 v_mfma_f32_16x16x32_bf16 a[252:255], v[136:139], v[144:147], a[252:255]
 s_waitcnt lgkmcnt(0)
 s_barrier
 v_mfma_f32_16x16x32_bf16 a[224:227], v[28:31], v[176:179], a[224:227]
 v_mov_b32 v145, s61
 v_mov_b32 v147, s61
 v_mfma_f32_16x16x32_bf16 a[228:231], v[28:31], v[180:183], a[228:231]
 v_mov_b32 v149, s61
 v_mov_b32 v151, s61
 v_mfma_f32_16x16x32_bf16 a[228:231], v[44:47], v[176:179], a[228:231]
 v_mov_b32 v153, s61
 v_mov_b32 v155, s61
 v_mfma_f32_16x16x32_bf16 a[232:235], v[28:31], v[184:187], a[232:235]
 v_mov_b32 v157, s61
 v_mov_b32 v159, s61
 v_mfma_f32_16x16x32_bf16 a[232:235], v[44:47], v[180:183], a[232:235]
 ds_write_b128 v13, a[224:227] offset:0
 v_mfma_f32_16x16x32_bf16 a[232:235], v[60:63], v[176:179], a[232:235]
 v_mfma_f32_16x16x32_bf16 a[236:239], v[28:31], v[188:191], a[236:239]
 ds_write_b128 v13, a[228:231] offset:1024
 v_mfma_f32_16x16x32_bf16 a[236:239], v[44:47], v[184:187], a[236:239]
 v_mfma_f32_16x16x32_bf16 a[236:239], v[60:63], v[180:183], a[236:239]
 v_mfma_f32_16x16x32_bf16 a[236:239], v[76:79], v[176:179], a[236:239]
 s_nop 2
 ds_write_b128 v13, a[232:235] offset:2048
 v_mfma_f32_16x16x32_bf16 a[240:243], v[28:31], v[192:195], a[240:243]
 v_mfma_f32_16x16x32_bf16 a[240:243], v[44:47], v[188:191], a[240:243]
 v_mfma_f32_16x16x32_bf16 a[240:243], v[60:63], v[184:187], a[240:243]
 v_mfma_f32_16x16x32_bf16 a[240:243], v[76:79], v[180:183], a[240:243]
 ds_write_b128 v13, a[236:239] offset:3072
 v_mfma_f32_16x16x32_bf16 a[240:243], v[92:95], v[176:179], a[240:243]
 v_mfma_f32_16x16x32_bf16 a[244:247], v[28:31], v[196:199], a[244:247]
 v_mfma_f32_16x16x32_bf16 a[244:247], v[44:47], v[192:195], a[244:247]
 v_mfma_f32_16x16x32_bf16 a[244:247], v[60:63], v[188:191], a[244:247]
 v_mfma_f32_16x16x32_bf16 a[244:247], v[76:79], v[184:187], a[244:247]
 s_nop 3
 ds_write_b128 v13, a[240:243] offset:4096
 v_mfma_f32_16x16x32_bf16 a[244:247], v[92:95], v[180:183], a[244:247]
 v_mfma_f32_16x16x32_bf16 a[244:247], v[108:111], v[176:179], a[244:247]
 v_mfma_f32_16x16x32_bf16 a[248:251], v[28:31], v[200:203], a[248:251]
 v_mfma_f32_16x16x32_bf16 a[248:251], v[44:47], v[196:199], a[248:251]
 v_mfma_f32_16x16x32_bf16 a[248:251], v[60:63], v[192:195], a[248:251]
 v_mfma_f32_16x16x32_bf16 a[248:251], v[76:79], v[188:191], a[248:251]
 s_nop 3
 ds_write_b128 v13, a[244:247] offset:5120
 v_mfma_f32_16x16x32_bf16 a[248:251], v[92:95], v[184:187], a[248:251]
 v_mfma_f32_16x16x32_bf16 a[248:251], v[108:111], v[180:183], a[248:251]
 v_mfma_f32_16x16x32_bf16 a[248:251], v[124:127], v[176:179], a[248:251]
 v_mfma_f32_16x16x32_bf16 a[252:255], v[28:31], v[204:207], a[252:255]
 v_mfma_f32_16x16x32_bf16 a[252:255], v[44:47], v[200:203], a[252:255]
 v_mfma_f32_16x16x32_bf16 a[252:255], v[60:63], v[196:199], a[252:255]
 v_mfma_f32_16x16x32_bf16 a[252:255], v[76:79], v[192:195], a[252:255]
 s_nop 3
 ds_write_b128 v13, a[248:251] offset:6144
 v_mfma_f32_16x16x32_bf16 a[252:255], v[92:95], v[188:191], a[252:255]
 v_mfma_f32_16x16x32_bf16 a[252:255], v[108:111], v[184:187], a[252:255]
 v_mfma_f32_16x16x32_bf16 a[252:255], v[124:127], v[180:183], a[252:255]
 v_mfma_f32_16x16x32_bf16 a[252:255], v[140:143], v[176:179], a[252:255]
 s_nop 7
 ds_write_b128 v13, a[252:255] offset:7168
 s_waitcnt lgkmcnt(0)
 s_barrier
 ds_read2st64_b64 v[16:19], v14 offset0:0 offset1:16
 ds_read2st64_b64 v[20:23], v14 offset0:32 offset1:48
 ds_read2st64_b64 v[24:27], v14 offset0:4 offset1:20
 ds_read2st64_b64 v[28:31], v14 offset0:36 offset1:52
 ds_read2st64_b64 v[32:35], v14 offset0:8 offset1:24
 ds_read2st64_b64 v[36:39], v14 offset0:40 offset1:56
 ds_read2st64_b64 v[40:43], v14 offset0:12 offset1:28
 ds_read2st64_b64 v[44:47], v14 offset0:44 offset1:60
 s_waitcnt lgkmcnt(6)
 v_pk_add_f32 v[16:17], v[16:17], v[18:19]
 v_pk_add_f32 v[20:21], v[20:21], v[22:23]
 v_cvt_pk_bf16_f32 v144, v16, v20
 v_cvt_pk_bf16_f32 v146, v17, v21
 buffer_store_dwordx4 v[144:147], v9, s[48:51], s4 offen sc1
 s_waitcnt lgkmcnt(4)
 v_pk_add_f32 v[24:25], v[24:25], v[26:27]
 v_pk_add_f32 v[28:29], v[28:29], v[30:31]
 v_cvt_pk_bf16_f32 v148, v24, v28
 v_cvt_pk_bf16_f32 v150, v25, v29
 buffer_store_dwordx4 v[148:151], v9, s[48:51], s5 offen sc1
 s_waitcnt lgkmcnt(2)
 v_pk_add_f32 v[32:33], v[32:33], v[34:35]
 v_pk_add_f32 v[36:37], v[36:37], v[38:39]
 v_cvt_pk_bf16_f32 v152, v32, v36
 v_cvt_pk_bf16_f32 v154, v33, v37
 buffer_store_dwordx4 v[152:155], v9, s[48:51], s6 offen sc1
 s_waitcnt lgkmcnt(0)
 v_pk_add_f32 v[40:41], v[40:41], v[42:43]
 v_pk_add_f32 v[44:45], v[44:45], v[46:47]
 v_cvt_pk_bf16_f32 v156, v40, v44
 v_cvt_pk_bf16_f32 v158, v41, v45
 buffer_store_dwordx4 v[156:159], v9, s[48:51], s7 offen sc1
 s_barrier
 v_bfe_u32 v250, v0, 4, 4
 v_lshl_add_u32 v250, v1, 4, v250
 v_lshlrev_b32 v250, 2, v250
 v_add_u32 v250, 163328, v250
 s_add_u32 s101, s53, 32768
 s_and_b32 m0, s101, 0x1ffff
 v_lshlrev_b32 v15, 6, v1
 v_add_u32 v15, 163328, v15
 s_mov_b32 s30, 0x3b000000
 s_mov_b32 s31, 0x3b000000
 buffer_load_dwordx4 v252, s[32:35], s16 offen  lds
 v_lshlrev_b32 v160, 16, v224
 v_and_b32 v161, s64, v224
 v_lshlrev_b32 v162, 16, v228
 v_and_b32 v163, s64, v228
 s_add_u32 m0, m0, 1024
 v_lshlrev_b32 v164, 16, v232
 v_and_b32 v165, s64, v232
 v_lshlrev_b32 v166, 16, v236
 v_and_b32 v167, s64, v236
 buffer_load_dwordx4 v252, s[36:39], s16 offen  lds
 v_lshlrev_b32 v168, 16, v226
 v_and_b32 v169, s64, v226
 v_lshlrev_b32 v170, 16, v230
 v_and_b32 v171, s64, v230
 s_add_u32 s101, s53, 40960
 s_and_b32 m0, s101, 0x1ffff
 v_lshlrev_b32 v172, 16, v234
 v_and_b32 v173, s64, v234
 v_lshlrev_b32 v174, 16, v238
 v_and_b32 v175, s64, v238
 buffer_load_dwordx4 v252, s[32:35], s17 offen  lds
 v_lshlrev_b32 v224, 16, v240
 v_and_b32 v225, s64, v240
 v_lshlrev_b32 v226, 16, v241
 v_and_b32 v227, s64, v241
 s_add_u32 m0, m0, 1024
 v_lshlrev_b32 v228, 16, v242
 v_and_b32 v229, s64, v242
 v_lshlrev_b32 v230, 16, v243
 v_and_b32 v231, s64, v243
 buffer_load_dwordx4 v252, s[36:39], s17 offen  lds
 v_lshlrev_b32 v232, 16, v244
 v_and_b32 v233, s64, v244
 v_lshlrev_b32 v234, 16, v245
 v_and_b32 v235, s64, v245
 v_lshlrev_b32 v236, 16, v246
 v_and_b32 v237, s64, v246
 v_lshlrev_b32 v238, 16, v247
 v_and_b32 v239, s64, v247
 v_pk_add_f32 v[184:185], v[224:225], v[226:227]
 v_pk_mul_f32 v[186:187], v[224:225], v[224:225]
 v_pk_add_f32 v[188:189], v[232:233], v[234:235]
 v_pk_mul_f32 v[190:191], v[232:233], v[232:233]
 v_pk_fma_f32 v[186:187], v[226:227], v[226:227], v[186:187]
 v_pk_fma_f32 v[190:191], v[234:235], v[234:235], v[190:191]
 v_pk_add_f32 v[184:185], v[184:185], v[228:229]
 v_pk_fma_f32 v[186:187], v[228:229], v[228:229], v[186:187]
 v_pk_add_f32 v[188:189], v[188:189], v[236:237]
 v_pk_fma_f32 v[190:191], v[236:237], v[236:237], v[190:191]
 v_pk_add_f32 v[184:185], v[184:185], v[230:231]
 v_pk_fma_f32 v[186:187], v[230:231], v[230:231], v[186:187]
 v_pk_add_f32 v[188:189], v[188:189], v[238:239]
 v_pk_fma_f32 v[190:191], v[238:239], v[238:239], v[190:191]
 v_add_f32 v176, v184, v185
 v_add_f32 v177, v186, v187
 v_add_f32 v178, v188, v189
 v_add_f32 v179, v190, v191
 v_lshlrev_b32 v240, 16, v220
 v_and_b32 v241, s64, v220
 v_permlane32_swap_b32 v176, v177
 v_permlane32_swap_b32 v178, v179
 v_add_f32 v176, v176, v177
 v_add_f32 v178, v178, v179
 v_lshlrev_b32 v242, 16, v221
 v_and_b32 v243, s64, v221
 v_permlane16_swap_b32 v176, v178
 v_add_f32 v176, v176, v178
 v_lshlrev_b32 v244, 16, v222
 v_and_b32 v245, s64, v222
 v_add_f32_dpp v176, v176, v176 row_ror:4 row_mask:0xf bank_mask:0xf
 v_lshlrev_b32 v246, 16, v223
 v_and_b32 v247, s64, v223
 v_add_f32_dpp v176, v176, v176 row_ror:8 row_mask:0xf bank_mask:0xf
 ds_write_b32 v250, v176 offset:0
 v_pk_mul_f32 v[160:161], v[160:161], v[240:241]
 v_pk_mul_f32 v[162:163], v[162:163], v[242:243]
 v_pk_mul_f32 v[164:165], v[164:165], v[244:245]
 v_pk_mul_f32 v[166:167], v[166:167], v[246:247]
 v_pk_mul_f32 v[168:169], v[168:169], v[240:241]
 v_pk_mul_f32 v[170:171], v[170:171], v[242:243]
 v_pk_mul_f32 v[172:173], v[172:173], v[244:245]
 v_pk_mul_f32 v[174:175], v[174:175], v[246:247]
 s_waitcnt lgkmcnt(0)
 s_barrier
 ds_read_b128 v[184:187], v15 offset:0
 ds_read_b128 v[188:191], v15 offset:16
 ds_read_b128 v[192:195], v15 offset:32
 ds_read_b128 v[196:199], v15 offset:48
 s_waitcnt lgkmcnt(0)
 v_pk_add_f32 v[184:185], v[184:185], v[188:189]
 v_pk_add_f32 v[192:193], v[192:193], v[196:197]
 v_pk_add_f32 v[186:187], v[186:187], v[190:191]
 v_pk_add_f32 v[194:195], v[194:195], v[198:199]
 v_pk_add_f32 v[176:177], v[184:185], v[192:193]
 v_pk_add_f32 v[178:179], v[186:187], v[194:195]
 v_pk_mul_f32 v[176:177], v[176:177], s[30:31]
 v_pk_mul_f32 v[178:179], v[178:179], s[30:31]
 v_pk_fma_f32 v[178:179], v[176:177], v[176:177], v[178:179] neg_lo:[1,0,0] neg_hi:[1,0,0]
 v_cvt_pk_bf16_f32 v180, v176, v177
 v_max_f32 v178, 0, v178
 v_max_f32 v179, 0, v179
 v_cvt_pk_bf16_f32 v181, v178, v179
 v_lshlrev_b32 v178, 16, v181
 v_and_b32 v179, s64, v181
 v_add_f32 v178, 0x3727c5ac, v178
 v_add_f32 v179, 0x3727c5ac, v179
 v_cvt_pk_bf16_f32 v181, v178, v179
 v_lshlrev_b32 v178, 16, v181
 v_and_b32 v179, s64, v181
 v_sqrt_f32 v178, v178
 v_sqrt_f32 v179, v179
 v_lshlrev_b32 v200, 16, v180
 v_cvt_pk_bf16_f32 v181, v178, v179
 v_lshlrev_b32 v178, 16, v181
 v_and_b32 v179, s64, v181
 v_rcp_f32 v202, v178
 v_rcp_f32 v203, v179
 v_and_b32 v201, s64, v180
 v_pk_mul_f32 v[200:201], v[200:201], v[202:203] neg_lo:[1,0] neg_hi:[1,0]
 v_pk_fma_f32 v[208:209], v[224:225], v[202:203], v[200:201] op_sel:[0,0,0] op_sel_hi:[1,0,0]
 v_pk_fma_f32 v[210:211], v[226:227], v[202:203], v[200:201] op_sel:[0,0,0] op_sel_hi:[1,0,0]
 v_pk_fma_f32 v[212:213], v[228:229], v[202:203], v[200:201] op_sel:[0,0,0] op_sel_hi:[1,0,0]
 v_pk_fma_f32 v[214:215], v[230:231], v[202:203], v[200:201] op_sel:[0,0,0] op_sel_hi:[1,0,0]
 v_pk_fma_f32 v[216:217], v[232:233], v[202:203], v[200:201] op_sel:[0,1,1] op_sel_hi:[1,1,1]
 v_pk_fma_f32 v[218:219], v[234:235], v[202:203], v[200:201] op_sel:[0,1,1] op_sel_hi:[1,1,1]
 v_pk_fma_f32 v[220:221], v[236:237], v[202:203], v[200:201] op_sel:[0,1,1] op_sel_hi:[1,1,1]
 v_pk_fma_f32 v[222:223], v[238:239], v[202:203], v[200:201] op_sel:[0,1,1] op_sel_hi:[1,1,1]
 v_pk_fma_f32 v[224:225], v[208:209], v[160:161], v[224:225]
 v_pk_fma_f32 v[226:227], v[210:211], v[162:163], v[226:227]
 v_pk_fma_f32 v[228:229], v[212:213], v[164:165], v[228:229]
 v_pk_fma_f32 v[230:231], v[214:215], v[166:167], v[230:231]
 v_pk_fma_f32 v[232:233], v[216:217], v[168:169], v[232:233]
 v_pk_fma_f32 v[234:235], v[218:219], v[170:171], v[234:235]
 v_pk_fma_f32 v[236:237], v[220:221], v[172:173], v[236:237]
 v_pk_fma_f32 v[238:239], v[222:223], v[174:175], v[238:239]
 v_mul_u32_u24 v14, 66560, v2
 v_lshl_add_u32 v14, v1, 4, v14
 v_lshlrev_b32 v5, 9, v2
 v_lshl_add_u32 v5, v1, 4, v5
 v_lshrrev_b32 v2, 2, v6
 v_add_u32 v2, 4096, v2
 s_lshr_b32 s52, s96, 2
 s_lshl_b32 s52, s52, 15
 s_and_b32 s3, s96, 3
 s_lshl_b32 s3, s3, 6
 s_add_u32 s52, s52, s3
 s_add_u32 s52, s52, 9699328
 s_lshl_b32 s73, s96, 2
 s_add_u32 s73, s73, s56
 s_lshl_b32 s57, s73, 7
 s_add_u32 s57, s57, 782080
 s_lshl_b32 s73, s73, 8
 s_add_u32 s73, s73, 520192
 s_mov_b32 s65, 11796480
 s_lshl_b32 s4, s96, 6
 s_add_u32 s4, s4, 5373952
 s_add_u32 s5, s4, 16640
 s_add_u32 s6, s4, 33280
 s_add_u32 s7, s4, 49920
 v_bfe_u32 v48, v0, 2, 4
 v_lshlrev_b32 v49, 7, v48
 v_lshl_add_u32 v49, v1, 3, v49
 v_add_u32 v49, s55, v49
 v_bfe_u32 v48, v0, 3, 2
 v_xor_b32 v50, 0, v48
 v_lshl_add_u32 v8, v50, 5, v49
 v_xor_b32 v50, 1, v48
 v_lshl_add_u32 v255, v50, 5, v49
 v_xor_b32 v50, 2, v48
 v_lshl_add_u32 v253, v50, 5, v49
 v_xor_b32 v50, 3, v48
 v_lshl_add_u32 v251, v50, 5, v49
 s_lshl_b32 s3, s59, 2
 s_add_u32 s3, s3, s56
 s_lshl_b32 s58, s3, 13
 s_add_u32 s58, s58, 524288
 s_lshl_b32 s3, s3, 16
 s_add_u32 s3, s3, 9699328
 s_add_u32 s66, s78, 0
 s_and_b32 s66, s66, 7
 s_lshl_b32 s87, s66, 7
 s_add_u32 s87, s87, s58
 s_lshl_b32 s66, s66, 12
 s_add_u32 s8, s66, s3
 s_add_u32 s66, s78, 1
 s_and_b32 s66, s66, 7
 s_lshl_b32 s88, s66, 7
 s_add_u32 s88, s88, s58
 s_lshl_b32 s66, s66, 12
 s_add_u32 s9, s66, s3
 s_add_u32 s66, s78, 2
 s_and_b32 s66, s66, 7
 s_lshl_b32 s89, s66, 7
 s_add_u32 s89, s89, s58
 s_lshl_b32 s66, s66, 12
 s_add_u32 s10, s66, s3
 s_add_u32 s66, s78, 3
 s_and_b32 s66, s66, 7
 s_lshl_b32 s90, s66, 7
 s_add_u32 s90, s90, s58
 s_lshl_b32 s66, s66, 12
 s_add_u32 s11, s66, s3
 s_add_u32 s66, s78, 4
 s_and_b32 s66, s66, 7
 s_lshl_b32 s91, s66, 7
 s_add_u32 s91, s91, s58
 s_lshl_b32 s66, s66, 12
 s_add_u32 s12, s66, s3
 s_add_u32 s66, s78, 5
 s_and_b32 s66, s66, 7
 s_lshl_b32 s92, s66, 7
 s_add_u32 s92, s92, s58
 s_lshl_b32 s66, s66, 12
 s_add_u32 s13, s66, s3
 s_add_u32 s66, s78, 6
 s_and_b32 s66, s66, 7
 s_lshl_b32 s93, s66, 7
 s_add_u32 s93, s93, s58
 s_lshl_b32 s66, s66, 12
 s_add_u32 s14, s66, s3
 s_add_u32 s66, s78, 7
 s_and_b32 s66, s66, 7
 s_lshl_b32 s94, s66, 7
 s_add_u32 s94, s94, s58
 s_lshl_b32 s66, s66, 12
 s_add_u32 s15, s66, s3
 v_bfe_u32 v248, v0, 2, 2
 v_lshlrev_b32 v248, 10, v248
 v_and_b32 v249, 48, v0
 v_add_u32 v248, v248, v249
 v_lshl_add_u32 v248, v1, 2, v248
 v_and_b32 v249, 31, v0
 v_lshlrev_b32 v249, 7, v249
 s_lshl_b32 s97, s59, 2
 s_add_u32 s97, s97, s56
 s_lshl_b32 s97, s97, 12
 s_add_u32 s97, s97, 786432
 v_add_u32 v48, s55, v6
 s_waitcnt vmcnt(8)
 ds_write_b128 v48, a[0:3] offset:0
 ds_write_b128 v48, a[4:7] offset:1024
 ds_write_b128 v48, a[8:11] offset:2048
 ds_write_b128 v48, a[12:15] offset:3072
 ds_read_b64_tr_b16 a[0:1], v8 offset:0
 ds_read_b64_tr_b16 a[4:5], v255 offset:0
 ds_read_b64_tr_b16 a[8:9], v253 offset:0
 ds_read_b64_tr_b16 a[12:13], v251 offset:0
 ds_read_b64_tr_b16 a[2:3], v8 offset:2048
 ds_read_b64_tr_b16 a[6:7], v255 offset:2048
 ds_read_b64_tr_b16 a[10:11], v253 offset:2048
 ds_read_b64_tr_b16 a[14:15], v251 offset:2048
 ds_write_b128 v48, a[16:19] offset:0
 ds_write_b128 v48, a[20:23] offset:1024
 ds_write_b128 v48, a[24:27] offset:2048
 ds_write_b128 v48, a[28:31] offset:3072
 ds_read_b64_tr_b16 a[16:17], v8 offset:0
 ds_read_b64_tr_b16 a[20:21], v255 offset:0
 ds_read_b64_tr_b16 a[24:25], v253 offset:0
 ds_read_b64_tr_b16 a[28:29], v251 offset:0
 ds_read_b64_tr_b16 a[18:19], v8 offset:2048
 ds_read_b64_tr_b16 a[22:23], v255 offset:2048
 ds_read_b64_tr_b16 a[26:27], v253 offset:2048
 ds_read_b64_tr_b16 a[30:31], v251 offset:2048
 buffer_load_dwordx4 v[64:67], v14, s[48:51], s4 offen sc1
 buffer_load_dwordx4 v[68:71], v14, s[48:51], s5 offen sc1
 buffer_load_dwordx4 v[72:75], v14, s[48:51], s6 offen sc1
 buffer_load_dwordx4 v[76:79], v14, s[48:51], s7 offen sc1
 s_barrier
 s_add_u32 s101, s53, 49152
 s_and_b32 m0, s101, 0x1ffff
 s_nop 0
 buffer_load_dwordx4 v252, s[32:35], s18 offen  lds
 s_add_u32 m0, m0, 1024
 s_nop 0
 buffer_load_dwordx4 v252, s[36:39], s18 offen  lds
 s_add_u32 s101, s53, 57344
 s_and_b32 m0, s101, 0x1ffff
 s_nop 0
 buffer_load_dwordx4 v252, s[32:35], s19 offen  lds
 s_add_u32 m0, m0, 1024
 s_nop 0
 buffer_load_dwordx4 v252, s[36:39], s19 offen  lds
 s_waitcnt vmcnt(7)
L_h2:
 v_xor_b32 v4, s61, v65
 v_bitop3_b32 v4, v4, v67, s61 bitop3:0xf6
 v_lshlrev_b32 v80, 16, v64
 v_and_b32 v81, s64, v64
 v_lshlrev_b32 v88, 16, v66
 v_and_b32 v89, s64, v66
 v_pk_fma_f32 v[80:81], v[208:209], v[80:81], v[224:225]
 v_pk_fma_f32 v[88:89], v[216:217], v[88:89], v[232:233]
 v_pk_mul_f32 v[122:123], v[80:81], v[80:81]
 v_pk_mul_f32 v[126:127], v[88:89], v[88:89]
 s_waitcnt vmcnt(6)
 v_bitop3_b32 v4, v4, v69, s61 bitop3:0xf6
 v_bitop3_b32 v4, v4, v71, s61 bitop3:0xf6
 v_lshlrev_b32 v82, 16, v68
 v_and_b32 v83, s64, v68
 v_lshlrev_b32 v90, 16, v70
 v_and_b32 v91, s64, v70
 v_pk_fma_f32 v[82:83], v[210:211], v[82:83], v[226:227]
 v_pk_fma_f32 v[90:91], v[218:219], v[90:91], v[234:235]
 v_pk_add_f32 v[120:121], v[80:81], v[82:83]
 v_pk_fma_f32 v[122:123], v[82:83], v[82:83], v[122:123]
 v_pk_add_f32 v[124:125], v[88:89], v[90:91]
 v_pk_fma_f32 v[126:127], v[90:91], v[90:91], v[126:127]
 s_waitcnt vmcnt(5)
 v_bitop3_b32 v4, v4, v73, s61 bitop3:0xf6
 v_bitop3_b32 v4, v4, v75, s61 bitop3:0xf6
 v_lshlrev_b32 v84, 16, v72
 v_and_b32 v85, s64, v72
 v_lshlrev_b32 v92, 16, v74
 v_and_b32 v93, s64, v74
 v_pk_fma_f32 v[84:85], v[212:213], v[84:85], v[228:229]
 v_pk_fma_f32 v[92:93], v[220:221], v[92:93], v[236:237]
 v_pk_add_f32 v[120:121], v[120:121], v[84:85]
 v_pk_fma_f32 v[122:123], v[84:85], v[84:85], v[122:123]
 v_pk_add_f32 v[124:125], v[124:125], v[92:93]
 v_pk_fma_f32 v[126:127], v[92:93], v[92:93], v[126:127]
 s_waitcnt vmcnt(4)
 v_bitop3_b32 v4, v4, v77, s61 bitop3:0xf6
 v_bitop3_b32 v4, v4, v79, s61 bitop3:0xf6
 v_cmp_ne_u32 vcc, 0, v4
 v_lshlrev_b32 v86, 16, v76
 v_and_b32 v87, s64, v76
 v_lshlrev_b32 v94, 16, v78
 v_and_b32 v95, s64, v78
 v_pk_fma_f32 v[86:87], v[214:215], v[86:87], v[230:231]
 v_pk_fma_f32 v[94:95], v[222:223], v[94:95], v[238:239]
 v_pk_add_f32 v[120:121], v[120:121], v[86:87]
 v_pk_fma_f32 v[122:123], v[86:87], v[86:87], v[122:123]
 v_pk_add_f32 v[124:125], v[124:125], v[94:95]
 v_pk_fma_f32 v[126:127], v[94:95], v[94:95], v[126:127]
 s_mov_b64 exec, -1
 s_cbranch_vccnz L_h2_r
L_h2_ok:
 v_add_f32 v112, v120, v121
 v_add_f32 v113, v122, v123
 v_add_f32 v114, v124, v125
 v_add_f32 v115, v126, v127
 v_cvt_pk_bf16_f32 v224, v80, v81
 v_cvt_pk_bf16_f32 v225, v82, v83
 v_permlane32_swap_b32 v112, v113
 v_permlane32_swap_b32 v114, v115
 v_add_f32 v112, v112, v113
 v_add_f32 v114, v114, v115
 v_cvt_pk_bf16_f32 v226, v84, v85
 v_cvt_pk_bf16_f32 v227, v86, v87
 v_permlane16_swap_b32 v112, v114
 v_add_f32 v112, v112, v114
 v_cvt_pk_bf16_f32 v228, v88, v89
 v_cvt_pk_bf16_f32 v229, v90, v91
 v_add_f32_dpp v112, v112, v112 row_ror:4 row_mask:0xf bank_mask:0xf
 v_cvt_pk_bf16_f32 v230, v92, v93
 v_cvt_pk_bf16_f32 v231, v94, v95
 v_add_f32_dpp v112, v112, v112 row_ror:8 row_mask:0xf bank_mask:0xf
 ds_write_b32 v250, v112 offset:256
 buffer_store_dwordx4 v[224:227], v3, s[48:51], s65 offen sc1
 buffer_store_dwordx4 v[228:231], v3, s[48:51], s65 offen offset:1024 sc1
 v_lshlrev_b32 v80, 16, v224
 v_and_b32 v81, s64, v224
 v_lshlrev_b32 v82, 16, v225
 v_and_b32 v83, s64, v225
 v_lshlrev_b32 v84, 16, v226
 v_and_b32 v85, s64, v226
 s_waitcnt lgkmcnt(0)
 s_barrier
 ds_read_b128 v[120:123], v15 offset:256
 ds_read_b128 v[124:127], v15 offset:272
 ds_read_b128 v[128:131], v15 offset:288
 ds_read_b128 v[132:135], v15 offset:304
 v_lshlrev_b32 v86, 16, v227
 v_and_b32 v87, s64, v227
 v_lshlrev_b32 v88, 16, v228
 v_and_b32 v89, s64, v228
 v_lshlrev_b32 v90, 16, v229
 v_and_b32 v91, s64, v229
 v_lshlrev_b32 v92, 16, v230
 v_and_b32 v93, s64, v230
 v_lshlrev_b32 v94, 16, v231
 v_and_b32 v95, s64, v231
 s_waitcnt lgkmcnt(0)
 v_pk_add_f32 v[120:121], v[120:121], v[124:125]
 v_pk_add_f32 v[128:129], v[128:129], v[132:133]
 v_pk_add_f32 v[122:123], v[122:123], v[126:127]
 v_pk_add_f32 v[130:131], v[130:131], v[134:135]
 v_pk_add_f32 v[112:113], v[120:121], v[128:129]
 v_pk_add_f32 v[114:115], v[122:123], v[130:131]
 v_pk_mul_f32 v[112:113], v[112:113], s[30:31]
 v_pk_mul_f32 v[114:115], v[114:115], s[30:31]
 v_pk_fma_f32 v[114:115], v[112:113], v[112:113], v[114:115] neg_lo:[1,0,0] neg_hi:[1,0,0]
 v_cvt_pk_bf16_f32 v116, v112, v113
 v_max_f32 v114, 0, v114
 v_max_f32 v115, 0, v115
 v_cvt_pk_bf16_f32 v117, v114, v115
 v_lshlrev_b32 v114, 16, v117
 v_and_b32 v115, s64, v117
 v_add_f32 v114, 0x3727c5ac, v114
 v_add_f32 v115, 0x3727c5ac, v115
 v_cvt_pk_bf16_f32 v117, v114, v115
 v_lshlrev_b32 v114, 16, v117
 v_and_b32 v115, s64, v117
 v_sqrt_f32 v114, v114
 v_sqrt_f32 v115, v115
 v_lshlrev_b32 v136, 16, v116
 v_cvt_pk_bf16_f32 v117, v114, v115
 v_lshlrev_b32 v114, 16, v117
 v_and_b32 v115, s64, v117
 v_rcp_f32 v138, v114
 v_rcp_f32 v139, v115
 v_and_b32 v137, s64, v116
 v_pk_mul_f32 v[136:137], v[136:137], v[138:139] neg_lo:[1,0] neg_hi:[1,0]
 v_pk_fma_f32 v[80:81], v[80:81], v[138:139], v[136:137] op_sel:[0,0,0] op_sel_hi:[1,0,0]
 v_pk_fma_f32 v[82:83], v[82:83], v[138:139], v[136:137] op_sel:[0,0,0] op_sel_hi:[1,0,0]
 v_pk_fma_f32 v[84:85], v[84:85], v[138:139], v[136:137] op_sel:[0,0,0] op_sel_hi:[1,0,0]
 v_pk_fma_f32 v[86:87], v[86:87], v[138:139], v[136:137] op_sel:[0,0,0] op_sel_hi:[1,0,0]
 v_cvt_pk_bf16_f32 v104, v80, v81
 v_cvt_pk_bf16_f32 v105, v82, v83
 v_cvt_pk_bf16_f32 v106, v84, v85
 v_cvt_pk_bf16_f32 v107, v86, v87
 buffer_store_dwordx4 v[104:107], v5, s[48:51], s52 offen offset:0 sc1
 v_xad_u32 v112, v104, v105, v106
 v_add_u32 v112, v112, v107
 v_pk_fma_f32 v[88:89], v[88:89], v[138:139], v[136:137] op_sel:[0,1,1] op_sel_hi:[1,1,1]
 v_pk_fma_f32 v[90:91], v[90:91], v[138:139], v[136:137] op_sel:[0,1,1] op_sel_hi:[1,1,1]
 v_pk_fma_f32 v[92:93], v[92:93], v[138:139], v[136:137] op_sel:[0,1,1] op_sel_hi:[1,1,1]
 v_pk_fma_f32 v[94:95], v[94:95], v[138:139], v[136:137] op_sel:[0,1,1] op_sel_hi:[1,1,1]
 v_cvt_pk_bf16_f32 v108, v88, v89
 v_cvt_pk_bf16_f32 v109, v90, v91
 v_cvt_pk_bf16_f32 v110, v92, v93
 v_cvt_pk_bf16_f32 v111, v94, v95
 buffer_store_dwordx4 v[108:111], v5, s[48:51], s52 offen offset:256 sc1
 v_xad_u32 v113, v108, v109, v110
 v_add_u32 v113, v113, v111
 v_add_u32 v114, v112, v113
 v_add_u32 v112, v112, v113
 s_nop 1
 v_permlane16_swap_b32 v112, v114
 v_add3_u32 v112, v112, v114, s61
 buffer_store_dword v112, v2, s[48:51], s73 offen sc1
 s_add_u32 s101, s53, 65536
 s_and_b32 m0, s101, 0x1ffff
 s_nop 0
 buffer_load_dwordx4 v252, s[32:35], s20 offen  lds
 s_add_u32 m0, m0, 1024
 s_nop 0
 buffer_load_dwordx4 v252, s[36:39], s20 offen  lds
 s_add_u32 s101, s53, 73728
 s_and_b32 m0, s101, 0x1ffff
 s_nop 0
 buffer_load_dwordx4 v252, s[32:35], s21 offen  lds
 s_add_u32 m0, m0, 1024
 s_nop 0
 buffer_load_dwordx4 v252, s[36:39], s21 offen  lds
 s_add_u32 s101, s53, 81920
 s_and_b32 m0, s101, 0x1ffff
 s_nop 0
 buffer_load_dwordx4 v252, s[32:35], s22 offen  lds
 s_add_u32 m0, m0, 1024
 s_nop 0
 buffer_load_dwordx4 v252, s[36:39], s22 offen  lds
 v_bfe_u32 v232, v0, 4, 2
 v_bfe_u32 v233, v0, 2, 2
 v_lshlrev_b32 v236, 11, v232
 v_lshl_add_u32 v236, v233, 7, v236
 v_lshl_add_u32 v236, v1, 3, v236
 v_bfe_u32 v234, v0, 3, 2
 v_lshl_add_u32 v221, v232, 8, v6
 v_add_u32 v223, 32768, v221
 v_xor_b32 v235, 0, v234
 v_lshl_add_u32 v12, v235, 5, v236
 v_xor_b32 v235, 1, v234
 v_lshl_add_u32 v13, v235, 5, v236
 v_xor_b32 v235, 2, v234
 v_lshl_add_u32 v14, v235, 5, v236
 v_xor_b32 v235, 3, v234
 v_lshl_add_u32 v15, v235, 5, v236
 v_lshrrev_b32 v232, 3, v0
 v_lshlrev_b32 v233, 10, v232
 v_and_b32 v234, 7, v0
 v_lshl_add_u32 v9, v234, 4, v233
 v_mul_u32_u24 v220, 280, v6
 v_add_u32 v4, 16, v6
 v_lshrrev_b32 v4, 7, v4
 v_lshl_add_u32 v220, v4, 25, v220
 v_lshlrev_b32 v7, 21, v6
 v_add_u32 v7, 4352, v7
 v_mov_b32 v10, s61
 s_or_b32 s3, s2, s56
 s_cmp_lg_u32 s3, 0
 s_cbranch_scc1 L_notag
 v_lshlrev_b32 v4, 21, v6
 buffer_store_dword v10, v4, s[48:51], 0 offen sc1
L_notag:
 s_add_u32 s101, s53, 90112
 s_and_b32 m0, s101, 0x1ffff
 s_nop 0
 buffer_load_dwordx4 v252, s[32:35], s23 offen  lds
 s_add_u32 m0, m0, 1024
 s_nop 0
 buffer_load_dwordx4 v252, s[36:39], s23 offen  lds
 s_add_u32 s101, s53, 98304
 s_and_b32 m0, s101, 0x1ffff
 s_nop 0
 buffer_load_dwordx4 v252, s[32:35], s24 offen  lds
 s_add_u32 m0, m0, 1024
 s_nop 0
 buffer_load_dwordx4 v252, s[36:39], s24 offen  lds
 s_add_u32 s101, s53, 106496
 s_and_b32 m0, s101, 0x1ffff
 s_nop 0
 buffer_load_dwordx4 v252, s[32:35], s25 offen  lds
 s_add_u32 m0, m0, 1024
 s_nop 0
 buffer_load_dwordx4 v252, s[36:39], s25 offen  lds
 s_add_u32 s101, s53, 114688
 s_and_b32 m0, s101, 0x1ffff
 s_nop 0
 buffer_load_dwordx4 v252, s[32:35], s26 offen  lds
 s_add_u32 m0, m0, 1024
 s_nop 0
 buffer_load_dwordx4 v252, s[36:39], s26 offen  lds
 s_add_u32 s101, s53, 122880
 s_and_b32 m0, s101, 0x1ffff
 s_nop 0
 buffer_load_dwordx4 v252, s[32:35], s27 offen  lds
 s_add_u32 m0, m0, 1024
 s_nop 0
 buffer_load_dwordx4 v252, s[36:39], s27 offen  lds
 s_waitcnt vmcnt(16)
 buffer_store_dword v10, v7, s[48:51], s57 offen sc1
 s_cmp_ge_u32 s67, 7
 s_cbranch_scc1 L_sia_i
 buffer_load_dwordx4 v[16:19], v221, s[48:51], s8 offen offset:0 sc1
 buffer_load_dwordx4 v[20:23], v221, s[48:51], s8 offen offset:256 sc1
 buffer_load_dwordx4 v[24:27], v221, s[48:51], s8 offen offset:2048 sc1
 buffer_load_dwordx4 v[28:31], v221, s[48:51], s8 offen offset:2304 sc1
 buffer_load_dword v208, v248, s[48:51], s87 offen sc1
 buffer_load_dwordx4 v[32:35], v221, s[48:51], s9 offen offset:0 sc1
 buffer_load_dwordx4 v[36:39], v221, s[48:51], s9 offen offset:256 sc1
 buffer_load_dwordx4 v[40:43], v221, s[48:51], s9 offen offset:2048 sc1
 buffer_load_dwordx4 v[44:47], v221, s[48:51], s9 offen offset:2304 sc1
 buffer_load_dword v209, v248, s[48:51], s88 offen sc1
L_sia:
 s_waitcnt vmcnt(11)
 s_barrier
 s_cmp_ge_u32 s67, 7
 s_cbranch_scc1 L_idle
 ds_read_b64_tr_b16 a[224:225], v12 offset:0
 ds_read_b64_tr_b16 a[226:227], v12 offset:512
 ds_read_b64_tr_b16 a[228:229], v12 offset:8192
 ds_read_b64_tr_b16 a[230:231], v12 offset:8704
 ds_read_b64_tr_b16 a[232:233], v12 offset:1024
 ds_read_b64_tr_b16 a[234:235], v12 offset:1536
 ds_read_b64_tr_b16 a[236:237], v12 offset:9216
 ds_read_b64_tr_b16 a[238:239], v12 offset:9728
 ds_read_b64_tr_b16 a[240:241], v13 offset:0
 ds_read_b64_tr_b16 a[242:243], v13 offset:512
 ds_read_b64_tr_b16 a[244:245], v13 offset:8192
 ds_read_b64_tr_b16 a[246:247], v13 offset:8704
 buffer_load_dwordx4 v[48:51], v221, s[48:51], s10 offen offset:0 sc1
 buffer_load_dwordx4 v[52:55], v221, s[48:51], s10 offen offset:256 sc1
 buffer_load_dwordx4 v[56:59], v221, s[48:51], s10 offen offset:2048 sc1
 buffer_load_dwordx4 v[60:63], v221, s[48:51], s10 offen offset:2304 sc1
 buffer_load_dword v210, v248, s[48:51], s89 offen sc1
 s_waitcnt vmcnt(10)
 v_xad_u32 v4, v16, v17, s61
 v_add3_u32 v4, v4, v18, v19
 v_xad_u32 v4, v20, v21, v4
 v_add3_u32 v4, v4, v22, v23
 v_xad_u32 v4, v24, v25, v4
 v_add3_u32 v4, v4, v26, v27
 v_xad_u32 v4, v28, v29, v4
 v_add3_u32 v4, v4, v30, v31
 v_cmp_ne_u32 vcc, v4, v208
 s_cbranch_vccnz L_hn0_r
L_hn0_b:
 s_waitcnt lgkmcnt(8)
 v_mfma_f32_16x16x32_bf16 v[80:83], a[224:227], v[16:19], 0
 ds_read_b64_tr_b16 a[248:249], v13 offset:1024
 buffer_load_dwordx4 v[64:67], v221, s[48:51], s11 offen offset:0 sc1
 v_mfma_f32_16x16x32_bf16 v[80:83], a[228:231], v[24:27], v[80:83]
 ds_read_b64_tr_b16 a[250:251], v13 offset:1536
 s_mul_i32 s3, s72, 250880
 s_add_u32 s3, s3, 13893632
 v_mfma_f32_16x16x32_bf16 v[96:99], a[224:227], v[20:23], 0
 ds_read_b64_tr_b16 a[252:253], v13 offset:9216
 buffer_load_dwordx4 v[68:71], v221, s[48:51], s11 offen offset:256 sc1
 v_mfma_f32_16x16x32_bf16 v[96:99], a[228:231], v[28:31], v[96:99]
 ds_read_b64_tr_b16 a[254:255], v13 offset:9728
 s_waitcnt lgkmcnt(8)
 v_mfma_f32_16x16x32_bf16 v[88:91], a[232:235], v[16:19], 0
 ds_read_b64_tr_b16 a[224:225], v14 offset:0
 buffer_load_dwordx4 v[72:75], v221, s[48:51], s11 offen offset:2048 sc1
 v_mfma_f32_16x16x32_bf16 v[88:91], a[236:239], v[24:27], v[88:91]
 ds_read_b64_tr_b16 a[226:227], v14 offset:512
 s_add_u32 m0, s55, 0
 s_lshr_b32 s66, s80, 16
 v_mfma_f32_16x16x32_bf16 v[104:107], a[232:235], v[20:23], 0
 ds_read_b64_tr_b16 a[228:229], v14 offset:8192
 buffer_load_dwordx4 v[76:79], v221, s[48:51], s11 offen offset:2304 sc1
 v_mfma_f32_16x16x32_bf16 v[104:107], a[236:239], v[28:31], v[104:107]
 ds_read_b64_tr_b16 a[230:231], v14 offset:8704
 s_waitcnt lgkmcnt(8)
 v_mfma_f32_16x16x32_bf16 v[84:87], a[240:243], v[16:19], 0
 ds_read_b64_tr_b16 a[232:233], v14 offset:1024
 buffer_load_dword v211, v248, s[48:51], s90 offen sc1
 v_mfma_f32_16x16x32_bf16 v[84:87], a[244:247], v[24:27], v[84:87]
 ds_read_b64_tr_b16 a[234:235], v14 offset:1536
 s_waitcnt vmcnt(10)
 v_xad_u32 v4, v32, v33, s61
 v_mfma_f32_16x16x32_bf16 v[100:103], a[240:243], v[20:23], 0
 ds_read_b64_tr_b16 a[236:237], v14 offset:9216
 v_add3_u32 v4, v4, v34, v35
 v_mfma_f32_16x16x32_bf16 v[100:103], a[244:247], v[28:31], v[100:103]
 ds_read_b64_tr_b16 a[238:239], v14 offset:9728
 s_waitcnt lgkmcnt(8)
 v_mfma_f32_16x16x32_bf16 v[92:95], a[248:251], v[16:19], 0
 ds_read_b64_tr_b16 a[240:241], v15 offset:0
 v_xad_u32 v4, v36, v37, v4
 v_mfma_f32_16x16x32_bf16 v[92:95], a[252:255], v[24:27], v[92:95]
 ds_read_b64_tr_b16 a[242:243], v15 offset:512
 v_add3_u32 v4, v4, v38, v39
 v_xad_u32 v4, v40, v41, v4
 v_mfma_f32_16x16x32_bf16 v[108:111], a[248:251], v[20:23], 0
 ds_read_b64_tr_b16 a[244:245], v15 offset:8192
 v_add3_u32 v4, v4, v42, v43
 v_mfma_f32_16x16x32_bf16 v[108:111], a[252:255], v[28:31], v[108:111]
 ds_read_b64_tr_b16 a[246:247], v15 offset:8704
 s_waitcnt lgkmcnt(8)
 v_mfma_f32_16x16x32_bf16 v[112:115], a[224:227], v[16:19], 0
 ds_read_b64_tr_b16 a[248:249], v15 offset:1024
 v_xad_u32 v4, v44, v45, v4
 v_mfma_f32_16x16x32_bf16 v[112:115], a[228:231], v[24:27], v[112:115]
 ds_read_b64_tr_b16 a[250:251], v15 offset:1536
 v_add3_u32 v4, v4, v46, v47
 v_cmp_ne_u32 vcc, v4, v209
 v_mfma_f32_16x16x32_bf16 v[128:131], a[224:227], v[20:23], 0
 ds_read_b64_tr_b16 a[252:253], v15 offset:9216
 buffer_load_dwordx4 v254, s[40:43], s81 offen lds
 v_mfma_f32_16x16x32_bf16 v[128:131], a[228:231], v[28:31], v[128:131]
 ds_read_b64_tr_b16 a[254:255], v15 offset:9728
 s_waitcnt lgkmcnt(8)
 v_mfma_f32_16x16x32_bf16 v[120:123], a[232:235], v[16:19], 0
 ds_read_b64_tr_b16 a[224:225], v12 offset:16384
 s_add_u32 m0, s55, 1024
 v_mfma_f32_16x16x32_bf16 v[120:123], a[236:239], v[24:27], v[120:123]
 ds_read_b64_tr_b16 a[226:227], v12 offset:16896
 s_cbranch_vccnz L_hn1_r
L_hn1_b:
 v_mfma_f32_16x16x32_bf16 v[136:139], a[232:235], v[20:23], 0
 ds_read_b64_tr_b16 a[228:229], v12 offset:24576
 s_add_u32 s100, s81, 8192
 v_mfma_f32_16x16x32_bf16 v[136:139], a[236:239], v[28:31], v[136:139]
 ds_read_b64_tr_b16 a[230:231], v12 offset:25088
 s_waitcnt lgkmcnt(8)
 v_mfma_f32_16x16x32_bf16 v[116:119], a[240:243], v[16:19], 0
 ds_read_b64_tr_b16 a[232:233], v12 offset:17408
 buffer_load_dwordx4 v254, s[40:43], s100 offen lds
 v_mfma_f32_16x16x32_bf16 v[116:119], a[244:247], v[24:27], v[116:119]
 ds_read_b64_tr_b16 a[234:235], v12 offset:17920
 s_add_u32 m0, s55, 2048
 s_add_u32 s100, s81, 16384
 v_mfma_f32_16x16x32_bf16 v[132:135], a[240:243], v[20:23], 0
 ds_read_b64_tr_b16 a[236:237], v12 offset:25600
 buffer_load_dwordx4 v254, s[40:43], s100 offen lds
 v_mfma_f32_16x16x32_bf16 v[132:135], a[244:247], v[28:31], v[132:135]
 ds_read_b64_tr_b16 a[238:239], v12 offset:26112
 s_waitcnt lgkmcnt(8)
 v_mfma_f32_16x16x32_bf16 v[124:127], a[248:251], v[16:19], 0
 ds_read_b64_tr_b16 a[240:241], v13 offset:16384
 s_mul_i32 s66, s66, 4480
 v_mfma_f32_16x16x32_bf16 v[124:127], a[252:255], v[24:27], v[124:127]
 ds_read_b64_tr_b16 a[242:243], v13 offset:16896
 s_add_u32 m0, s55, 3072
 s_add_u32 s16, s66, s3
 v_mfma_f32_16x16x32_bf16 v[140:143], a[248:251], v[20:23], 0
 ds_read_b64_tr_b16 a[244:245], v13 offset:24576
 s_add_u32 s23, s16, 125440
 v_mfma_f32_16x16x32_bf16 v[140:143], a[252:255], v[28:31], v[140:143]
 ds_read_b64_tr_b16 a[246:247], v13 offset:25088
 s_waitcnt lgkmcnt(8)
 v_mfma_f32_16x16x32_bf16 v[80:83], a[224:227], v[32:35], v[80:83]
 ds_read_b64_tr_b16 a[248:249], v13 offset:17408
 buffer_load_dwordx4 v[16:19], v221, s[48:51], s12 offen offset:0 sc1
 v_mfma_f32_16x16x32_bf16 v[80:83], a[228:231], v[40:43], v[80:83]
 ds_read_b64_tr_b16 a[250:251], v13 offset:17920
 s_add_u32 s100, s81, 24576
 s_lshr_b32 s66, s81, 16
 v_mfma_f32_16x16x32_bf16 v[96:99], a[224:227], v[36:39], v[96:99]
 ds_read_b64_tr_b16 a[252:253], v13 offset:25600
 buffer_load_dwordx4 v[20:23], v221, s[48:51], s12 offen offset:256 sc1
 v_mfma_f32_16x16x32_bf16 v[96:99], a[228:231], v[44:47], v[96:99]
 ds_read_b64_tr_b16 a[254:255], v13 offset:26112
 s_waitcnt lgkmcnt(8)
 v_mfma_f32_16x16x32_bf16 v[88:91], a[232:235], v[32:35], v[88:91]
 ds_read_b64_tr_b16 a[224:225], v14 offset:16384
 buffer_load_dwordx4 v[24:27], v221, s[48:51], s12 offen offset:2048 sc1
 v_mfma_f32_16x16x32_bf16 v[88:91], a[236:239], v[40:43], v[88:91]
 ds_read_b64_tr_b16 a[226:227], v14 offset:16896
 s_mul_i32 s66, s66, 4480
 s_add_u32 s17, s66, s3
 v_mfma_f32_16x16x32_bf16 v[104:107], a[232:235], v[36:39], v[104:107]
 ds_read_b64_tr_b16 a[228:229], v14 offset:24576
 buffer_load_dwordx4 v[28:31], v221, s[48:51], s12 offen offset:2304 sc1
 v_mfma_f32_16x16x32_bf16 v[104:107], a[236:239], v[44:47], v[104:107]
 ds_read_b64_tr_b16 a[230:231], v14 offset:25088
 s_waitcnt lgkmcnt(8)
 v_mfma_f32_16x16x32_bf16 v[84:87], a[240:243], v[32:35], v[84:87]
 ds_read_b64_tr_b16 a[232:233], v14 offset:17408
 buffer_load_dword v208, v248, s[48:51], s91 offen sc1
 v_mfma_f32_16x16x32_bf16 v[84:87], a[244:247], v[40:43], v[84:87]
 ds_read_b64_tr_b16 a[234:235], v14 offset:17920
 s_waitcnt vmcnt(13)
 v_xad_u32 v4, v48, v49, s61
 v_mfma_f32_16x16x32_bf16 v[100:103], a[240:243], v[36:39], v[100:103]
 ds_read_b64_tr_b16 a[236:237], v14 offset:25600
 v_add3_u32 v4, v4, v50, v51
 v_mfma_f32_16x16x32_bf16 v[100:103], a[244:247], v[44:47], v[100:103]
 ds_read_b64_tr_b16 a[238:239], v14 offset:26112
 s_waitcnt lgkmcnt(8)
 v_mfma_f32_16x16x32_bf16 v[92:95], a[248:251], v[32:35], v[92:95]
 ds_read_b64_tr_b16 a[240:241], v15 offset:16384
 v_xad_u32 v4, v52, v53, v4
 v_mfma_f32_16x16x32_bf16 v[92:95], a[252:255], v[40:43], v[92:95]
 ds_read_b64_tr_b16 a[242:243], v15 offset:16896
 v_add3_u32 v4, v4, v54, v55
 v_xad_u32 v4, v56, v57, v4
 v_mfma_f32_16x16x32_bf16 v[108:111], a[248:251], v[36:39], v[108:111]
 ds_read_b64_tr_b16 a[244:245], v15 offset:24576
 v_add3_u32 v4, v4, v58, v59
 v_mfma_f32_16x16x32_bf16 v[108:111], a[252:255], v[44:47], v[108:111]
 ds_read_b64_tr_b16 a[246:247], v15 offset:25088
 s_waitcnt lgkmcnt(8)
 v_mfma_f32_16x16x32_bf16 v[112:115], a[224:227], v[32:35], v[112:115]
 ds_read_b64_tr_b16 a[248:249], v15 offset:17408
 v_xad_u32 v4, v60, v61, v4
 v_mfma_f32_16x16x32_bf16 v[112:115], a[228:231], v[40:43], v[112:115]
 ds_read_b64_tr_b16 a[250:251], v15 offset:17920
 v_add3_u32 v4, v4, v62, v63
 v_cmp_ne_u32 vcc, v4, v210
 v_mfma_f32_16x16x32_bf16 v[128:131], a[224:227], v[36:39], v[128:131]
 ds_read_b64_tr_b16 a[252:253], v15 offset:25600
 buffer_load_dwordx4 v254, s[40:43], s100 offen lds
 v_mfma_f32_16x16x32_bf16 v[128:131], a[228:231], v[44:47], v[128:131]
 ds_read_b64_tr_b16 a[254:255], v15 offset:26112
 s_waitcnt lgkmcnt(8)
 v_mfma_f32_16x16x32_bf16 v[120:123], a[232:235], v[32:35], v[120:123]
 ds_read_b64_tr_b16 a[224:225], v12 offset:32768
 s_add_u32 m0, s55, 4096
 v_mfma_f32_16x16x32_bf16 v[120:123], a[236:239], v[40:43], v[120:123]
 ds_read_b64_tr_b16 a[226:227], v12 offset:33280
 s_cbranch_vccnz L_hn2_r
L_hn2_b:
 v_mfma_f32_16x16x32_bf16 v[136:139], a[232:235], v[36:39], v[136:139]
 ds_read_b64_tr_b16 a[228:229], v12 offset:40960
 s_add_u32 s100, s81, 32768
 v_mfma_f32_16x16x32_bf16 v[136:139], a[236:239], v[44:47], v[136:139]
 ds_read_b64_tr_b16 a[230:231], v12 offset:41472
 s_waitcnt lgkmcnt(8)
 v_mfma_f32_16x16x32_bf16 v[116:119], a[240:243], v[32:35], v[116:119]
 ds_read_b64_tr_b16 a[232:233], v12 offset:33792
 buffer_load_dwordx4 v254, s[40:43], s100 offen lds
 v_mfma_f32_16x16x32_bf16 v[116:119], a[244:247], v[40:43], v[116:119]
 ds_read_b64_tr_b16 a[234:235], v12 offset:34304
 s_add_u32 m0, s55, 5120
 s_add_u32 s100, s81, 40960
 v_mfma_f32_16x16x32_bf16 v[132:135], a[240:243], v[36:39], v[132:135]
 ds_read_b64_tr_b16 a[236:237], v12 offset:41984
 buffer_load_dwordx4 v254, s[40:43], s100 offen lds
 v_mfma_f32_16x16x32_bf16 v[132:135], a[244:247], v[44:47], v[132:135]
 ds_read_b64_tr_b16 a[238:239], v12 offset:42496
 s_waitcnt lgkmcnt(8)
 v_mfma_f32_16x16x32_bf16 v[124:127], a[248:251], v[32:35], v[124:127]
 ds_read_b64_tr_b16 a[240:241], v13 offset:32768
 buffer_load_dword v5, v249, s[48:51], s97 offen sc1
 v_mfma_f32_16x16x32_bf16 v[124:127], a[252:255], v[40:43], v[124:127]
 ds_read_b64_tr_b16 a[242:243], v13 offset:33280
 s_waitcnt vmcnt(10)
 ds_read_b64_tr_b16 a[32:33], v8 offset:0
 v_mfma_f32_16x16x32_bf16 v[140:143], a[248:251], v[36:39], v[140:143]
 ds_read_b64_tr_b16 a[244:245], v13 offset:40960
 s_add_u32 s24, s17, 125440
 v_mfma_f32_16x16x32_bf16 v[140:143], a[252:255], v[44:47], v[140:143]
 ds_read_b64_tr_b16 a[246:247], v13 offset:41472
 s_waitcnt lgkmcnt(9)
 v_mfma_f32_16x16x32_bf16 v[80:83], a[224:227], v[48:51], v[80:83]
 ds_read_b64_tr_b16 a[248:249], v13 offset:33792
 buffer_load_dwordx4 v[32:35], v221, s[48:51], s13 offen offset:0 sc1
 v_mfma_f32_16x16x32_bf16 v[80:83], a[228:231], v[56:59], v[80:83]
 ds_read_b64_tr_b16 a[250:251], v13 offset:34304
 ds_read_b64_tr_b16 a[36:37], v255 offset:0
 s_lshr_b32 s66, s82, 16
 v_mfma_f32_16x16x32_bf16 v[96:99], a[224:227], v[52:55], v[96:99]
 ds_read_b64_tr_b16 a[252:253], v13 offset:41984
 buffer_load_dwordx4 v[36:39], v221, s[48:51], s13 offen offset:256 sc1
 v_mfma_f32_16x16x32_bf16 v[96:99], a[228:231], v[60:63], v[96:99]
 ds_read_b64_tr_b16 a[254:255], v13 offset:42496
 s_waitcnt lgkmcnt(10)
 v_mfma_f32_16x16x32_bf16 v[88:91], a[232:235], v[48:51], v[88:91]
 ds_read_b64_tr_b16 a[224:225], v14 offset:32768
 buffer_load_dwordx4 v[40:43], v221, s[48:51], s13 offen offset:2048 sc1
 v_mfma_f32_16x16x32_bf16 v[88:91], a[236:239], v[56:59], v[88:91]
 ds_read_b64_tr_b16 a[226:227], v14 offset:33280
 ds_read_b64_tr_b16 a[40:41], v253 offset:0
 s_mul_i32 s66, s66, 4480
 v_mfma_f32_16x16x32_bf16 v[104:107], a[232:235], v[52:55], v[104:107]
 ds_read_b64_tr_b16 a[228:229], v14 offset:40960
 buffer_load_dwordx4 v[44:47], v221, s[48:51], s13 offen offset:2304 sc1
 v_mfma_f32_16x16x32_bf16 v[104:107], a[236:239], v[60:63], v[104:107]
 ds_read_b64_tr_b16 a[230:231], v14 offset:41472
 s_waitcnt lgkmcnt(10)
 v_mfma_f32_16x16x32_bf16 v[84:87], a[240:243], v[48:51], v[84:87]
 ds_read_b64_tr_b16 a[232:233], v14 offset:33792
 buffer_load_dword v209, v248, s[48:51], s92 offen sc1
 v_mfma_f32_16x16x32_bf16 v[84:87], a[244:247], v[56:59], v[84:87]
 ds_read_b64_tr_b16 a[234:235], v14 offset:34304
 v_xad_u32 v4, v64, v65, s61
 v_add3_u32 v4, v4, v66, v67
 v_mfma_f32_16x16x32_bf16 v[100:103], a[240:243], v[52:55], v[100:103]
 ds_read_b64_tr_b16 a[236:237], v14 offset:41984
 v_xad_u32 v4, v68, v69, v4
 v_mfma_f32_16x16x32_bf16 v[100:103], a[244:247], v[60:63], v[100:103]
 ds_read_b64_tr_b16 a[238:239], v14 offset:42496
 s_waitcnt lgkmcnt(9)
 v_mfma_f32_16x16x32_bf16 v[92:95], a[248:251], v[48:51], v[92:95]
 ds_read_b64_tr_b16 a[240:241], v15 offset:32768
 v_add3_u32 v4, v4, v70, v71
 v_mfma_f32_16x16x32_bf16 v[92:95], a[252:255], v[56:59], v[92:95]
 ds_read_b64_tr_b16 a[242:243], v15 offset:33280
 v_xad_u32 v4, v72, v73, v4
 v_add3_u32 v4, v4, v74, v75
 v_mfma_f32_16x16x32_bf16 v[108:111], a[248:251], v[52:55], v[108:111]
 ds_read_b64_tr_b16 a[244:245], v15 offset:40960
 v_xad_u32 v4, v76, v77, v4
 v_mfma_f32_16x16x32_bf16 v[108:111], a[252:255], v[60:63], v[108:111]
 ds_read_b64_tr_b16 a[246:247], v15 offset:41472
 s_waitcnt lgkmcnt(8)
 v_mfma_f32_16x16x32_bf16 v[112:115], a[224:227], v[48:51], v[112:115]
 ds_read_b64_tr_b16 a[248:249], v15 offset:33792
 v_add3_u32 v4, v4, v78, v79
 v_mfma_f32_16x16x32_bf16 v[112:115], a[228:231], v[56:59], v[112:115]
 ds_read_b64_tr_b16 a[250:251], v15 offset:34304
 v_cmp_ne_u32 vcc, v4, v211
 ds_read_b64_tr_b16 a[44:45], v251 offset:0
 v_mfma_f32_16x16x32_bf16 v[128:131], a[224:227], v[52:55], v[128:131]
 ds_read_b64_tr_b16 a[252:253], v15 offset:41984
 s_add_u32 m0, s55, 6144
 v_mfma_f32_16x16x32_bf16 v[128:131], a[228:231], v[60:63], v[128:131]
 ds_read_b64_tr_b16 a[254:255], v15 offset:42496
 s_waitcnt lgkmcnt(9)
 v_mfma_f32_16x16x32_bf16 v[120:123], a[232:235], v[48:51], v[120:123]
 ds_read_b64_tr_b16 a[224:225], v12 offset:49152
 s_add_u32 s100, s81, 49152
 v_mfma_f32_16x16x32_bf16 v[120:123], a[236:239], v[56:59], v[120:123]
 ds_read_b64_tr_b16 a[226:227], v12 offset:49664
 s_cbranch_vccnz L_hn3_r
L_hn3_b:
 v_mfma_f32_16x16x32_bf16 v[136:139], a[232:235], v[52:55], v[136:139]
 ds_read_b64_tr_b16 a[228:229], v12 offset:57344
 buffer_load_dwordx4 v254, s[40:43], s100 offen lds
 v_mfma_f32_16x16x32_bf16 v[136:139], a[236:239], v[60:63], v[136:139]
 ds_read_b64_tr_b16 a[230:231], v12 offset:57856
 s_waitcnt lgkmcnt(9)
 v_mfma_f32_16x16x32_bf16 v[116:119], a[240:243], v[48:51], v[116:119]
 ds_read_b64_tr_b16 a[232:233], v12 offset:50176
 s_add_u32 m0, s55, 7168
 v_mfma_f32_16x16x32_bf16 v[116:119], a[244:247], v[56:59], v[116:119]
 ds_read_b64_tr_b16 a[234:235], v12 offset:50688
 s_add_u32 s100, s81, 57344
 s_add_u32 s18, s66, s3
 v_mfma_f32_16x16x32_bf16 v[132:135], a[240:243], v[52:55], v[132:135]
 ds_read_b64_tr_b16 a[236:237], v12 offset:58368
 s_add_u32 s25, s18, 125440
 v_mfma_f32_16x16x32_bf16 v[132:135], a[244:247], v[60:63], v[132:135]
 ds_read_b64_tr_b16 a[238:239], v12 offset:58880
 s_waitcnt lgkmcnt(8)
 v_mfma_f32_16x16x32_bf16 v[124:127], a[248:251], v[48:51], v[124:127]
 ds_read_b64_tr_b16 a[240:241], v13 offset:49152
 buffer_load_dwordx4 v254, s[40:43], s100 offen lds
 v_mfma_f32_16x16x32_bf16 v[124:127], a[252:255], v[56:59], v[124:127]
 ds_read_b64_tr_b16 a[242:243], v13 offset:49664
 s_waitcnt vmcnt(10)
 s_lshr_b32 s66, s83, 16
 v_mfma_f32_16x16x32_bf16 v[140:143], a[248:251], v[52:55], v[140:143]
 ds_read_b64_tr_b16 a[244:245], v13 offset:57344
 s_mul_i32 s66, s66, 4480
 v_mfma_f32_16x16x32_bf16 v[140:143], a[252:255], v[60:63], v[140:143]
 ds_read_b64_tr_b16 a[246:247], v13 offset:57856
 s_waitcnt lgkmcnt(8)
 v_mfma_f32_16x16x32_bf16 v[80:83], a[224:227], v[64:67], v[80:83]
 ds_read_b64_tr_b16 a[248:249], v13 offset:50176
 buffer_load_dwordx4 v[48:51], v221, s[48:51], s14 offen offset:0 sc1
 v_mfma_f32_16x16x32_bf16 v[80:83], a[228:231], v[72:75], v[80:83]
 ds_read_b64_tr_b16 a[250:251], v13 offset:50688
 ds_read_b64_tr_b16 a[34:35], v8 offset:2048
 s_add_u32 s19, s66, s3
 v_mfma_f32_16x16x32_bf16 v[96:99], a[224:227], v[68:71], v[96:99]
 ds_read_b64_tr_b16 a[252:253], v13 offset:58368
 buffer_load_dwordx4 v[52:55], v221, s[48:51], s14 offen offset:256 sc1
 v_mfma_f32_16x16x32_bf16 v[96:99], a[228:231], v[76:79], v[96:99]
 ds_read_b64_tr_b16 a[254:255], v13 offset:58880
 s_waitcnt lgkmcnt(9)
 v_mfma_f32_16x16x32_bf16 v[88:91], a[232:235], v[64:67], v[88:91]
 ds_read_b64_tr_b16 a[224:225], v14 offset:49152
 buffer_load_dwordx4 v[56:59], v221, s[48:51], s14 offen offset:2048 sc1
 v_mfma_f32_16x16x32_bf16 v[88:91], a[236:239], v[72:75], v[88:91]
 ds_read_b64_tr_b16 a[226:227], v14 offset:49664
 ds_read_b64_tr_b16 a[38:39], v255 offset:2048
 s_add_u32 s26, s19, 125440
 v_mfma_f32_16x16x32_bf16 v[104:107], a[232:235], v[68:71], v[104:107]
 ds_read_b64_tr_b16 a[228:229], v14 offset:57344
 buffer_load_dwordx4 v[60:63], v221, s[48:51], s14 offen offset:2304 sc1
 v_mfma_f32_16x16x32_bf16 v[104:107], a[236:239], v[76:79], v[104:107]
 ds_read_b64_tr_b16 a[230:231], v14 offset:57856
 s_waitcnt lgkmcnt(10)
 v_mfma_f32_16x16x32_bf16 v[84:87], a[240:243], v[64:67], v[84:87]
 ds_read_b64_tr_b16 a[232:233], v14 offset:50176
 buffer_load_dword v210, v248, s[48:51], s93 offen sc1
 v_mfma_f32_16x16x32_bf16 v[84:87], a[244:247], v[72:75], v[84:87]
 ds_read_b64_tr_b16 a[234:235], v14 offset:50688
 v_xad_u32 v4, v16, v17, s61
 v_add3_u32 v4, v4, v18, v19
 v_mfma_f32_16x16x32_bf16 v[100:103], a[240:243], v[68:71], v[100:103]
 ds_read_b64_tr_b16 a[236:237], v14 offset:58368
 v_xad_u32 v4, v20, v21, v4
 v_mfma_f32_16x16x32_bf16 v[100:103], a[244:247], v[76:79], v[100:103]
 ds_read_b64_tr_b16 a[238:239], v14 offset:58880
 s_waitcnt lgkmcnt(9)
 v_mfma_f32_16x16x32_bf16 v[92:95], a[248:251], v[64:67], v[92:95]
 ds_read_b64_tr_b16 a[240:241], v15 offset:49152
 v_add3_u32 v4, v4, v22, v23
 v_mfma_f32_16x16x32_bf16 v[92:95], a[252:255], v[72:75], v[92:95]
 ds_read_b64_tr_b16 a[242:243], v15 offset:49664
 v_xad_u32 v4, v24, v25, v4
 v_add3_u32 v4, v4, v26, v27
 v_mfma_f32_16x16x32_bf16 v[108:111], a[248:251], v[68:71], v[108:111]
 ds_read_b64_tr_b16 a[244:245], v15 offset:57344
 v_xad_u32 v4, v28, v29, v4
 v_mfma_f32_16x16x32_bf16 v[108:111], a[252:255], v[76:79], v[108:111]
 ds_read_b64_tr_b16 a[246:247], v15 offset:57856
 s_waitcnt lgkmcnt(8)
 v_mfma_f32_16x16x32_bf16 v[112:115], a[224:227], v[64:67], v[112:115]
 ds_read_b64_tr_b16 a[248:249], v15 offset:50176
 v_add3_u32 v4, v4, v30, v31
 v_mfma_f32_16x16x32_bf16 v[112:115], a[228:231], v[72:75], v[112:115]
 ds_read_b64_tr_b16 a[250:251], v15 offset:50688
 v_cmp_ne_u32 vcc, v4, v208
 ds_read_b64_tr_b16 a[42:43], v253 offset:2048
 v_mfma_f32_16x16x32_bf16 v[128:131], a[224:227], v[68:71], v[128:131]
 ds_read_b64_tr_b16 a[252:253], v15 offset:58368
 ds_read_b64_tr_b16 a[46:47], v251 offset:2048
 v_mfma_f32_16x16x32_bf16 v[128:131], a[228:231], v[76:79], v[128:131]
 ds_read_b64_tr_b16 a[254:255], v15 offset:58880
 s_waitcnt lgkmcnt(10)
 v_mfma_f32_16x16x32_bf16 v[120:123], a[232:235], v[64:67], v[120:123]
 v_xor_b32 v12, 0x10000, v12
 ds_read_b64_tr_b16 a[224:225], v12 offset:0
 v_mfma_f32_16x16x32_bf16 v[120:123], a[236:239], v[72:75], v[120:123]
 ds_read_b64_tr_b16 a[226:227], v12 offset:512
 s_cbranch_vccnz L_hn4_r
L_hn4_b:
 v_mfma_f32_16x16x32_bf16 v[136:139], a[232:235], v[68:71], v[136:139]
 ds_read_b64_tr_b16 a[228:229], v12 offset:8192
 s_waitcnt vmcnt(12)
 v_mfma_f32_16x16x32_bf16 v[136:139], a[236:239], v[76:79], v[136:139]
 ds_read_b64_tr_b16 a[230:231], v12 offset:8704
 s_waitcnt lgkmcnt(10)
 v_mfma_f32_16x16x32_bf16 v[116:119], a[240:243], v[64:67], v[116:119]
 ds_read_b64_tr_b16 a[232:233], v12 offset:1024
 v_cmp_ne_u32 vcc, s61, v5
 v_mfma_f32_16x16x32_bf16 v[116:119], a[244:247], v[72:75], v[116:119]
 ds_read_b64_tr_b16 a[234:235], v12 offset:1536
 s_add_u32 m0, s55, 0
 s_nop 0
 buffer_load_dwordx4 v254, s[40:43], s82 offen lds
 v_mfma_f32_16x16x32_bf16 v[132:135], a[240:243], v[68:71], v[132:135]
 ds_read_b64_tr_b16 a[236:237], v12 offset:9216
 s_add_u32 m0, s55, 1024
 v_mfma_f32_16x16x32_bf16 v[132:135], a[244:247], v[76:79], v[132:135]
 ds_read_b64_tr_b16 a[238:239], v12 offset:9728
 s_waitcnt lgkmcnt(8)
 v_mfma_f32_16x16x32_bf16 v[124:127], a[248:251], v[64:67], v[124:127]
 v_xor_b32 v13, 0x10000, v13
 ds_read_b64_tr_b16 a[240:241], v13 offset:0
 v_mfma_f32_16x16x32_bf16 v[124:127], a[252:255], v[72:75], v[124:127]
 ds_read_b64_tr_b16 a[242:243], v13 offset:512
 s_cbranch_vccnz L_fp_r
L_fp_b:
 v_mfma_f32_16x16x32_bf16 v[140:143], a[248:251], v[68:71], v[140:143]
 ds_read_b64_tr_b16 a[244:245], v13 offset:8192
 s_add_u32 s100, s82, 8192
 v_mfma_f32_16x16x32_bf16 v[140:143], a[252:255], v[76:79], v[140:143]
 ds_read_b64_tr_b16 a[246:247], v13 offset:8704
 s_waitcnt lgkmcnt(8)
 v_mfma_f32_16x16x32_bf16 v[80:83], a[224:227], v[16:19], v[80:83]
 ds_read_b64_tr_b16 a[248:249], v13 offset:1024
 buffer_load_dwordx4 v[64:67], v221, s[48:51], s15 offen offset:0 sc1
 v_mfma_f32_16x16x32_bf16 v[80:83], a[228:231], v[24:27], v[80:83]
 ds_read_b64_tr_b16 a[250:251], v13 offset:1536
 s_lshr_b32 s66, s84, 16
 s_mul_i32 s66, s66, 4480
 v_mfma_f32_16x16x32_bf16 v[96:99], a[224:227], v[20:23], v[96:99]
 ds_read_b64_tr_b16 a[252:253], v13 offset:9216
 buffer_load_dwordx4 v[68:71], v221, s[48:51], s15 offen offset:256 sc1
 v_mfma_f32_16x16x32_bf16 v[96:99], a[228:231], v[28:31], v[96:99]
 ds_read_b64_tr_b16 a[254:255], v13 offset:9728
 s_waitcnt lgkmcnt(8)
 v_mfma_f32_16x16x32_bf16 v[88:91], a[232:235], v[16:19], v[88:91]
 v_xor_b32 v14, 0x10000, v14
 ds_read_b64_tr_b16 a[224:225], v14 offset:0
 v_mfma_f32_16x16x32_bf16 v[88:91], a[236:239], v[24:27], v[88:91]
 ds_read_b64_tr_b16 a[226:227], v14 offset:512
 buffer_load_dwordx4 v[72:75], v221, s[48:51], s15 offen offset:2048 sc1
 s_add_u32 s20, s66, s3
 v_mfma_f32_16x16x32_bf16 v[104:107], a[232:235], v[20:23], v[104:107]
 ds_read_b64_tr_b16 a[228:229], v14 offset:8192
 s_add_u32 s27, s20, 125440
 v_mfma_f32_16x16x32_bf16 v[104:107], a[236:239], v[28:31], v[104:107]
 ds_read_b64_tr_b16 a[230:231], v14 offset:8704
 s_waitcnt lgkmcnt(8)
 v_mfma_f32_16x16x32_bf16 v[84:87], a[240:243], v[16:19], v[84:87]
 ds_read_b64_tr_b16 a[232:233], v14 offset:1024
 buffer_load_dwordx4 v[76:79], v221, s[48:51], s15 offen offset:2304 sc1
 v_mfma_f32_16x16x32_bf16 v[84:87], a[244:247], v[24:27], v[84:87]
 ds_read_b64_tr_b16 a[234:235], v14 offset:1536
 s_waitcnt vmcnt(12)
 v_xad_u32 v4, v32, v33, s61
 v_mfma_f32_16x16x32_bf16 v[100:103], a[240:243], v[20:23], v[100:103]
 ds_read_b64_tr_b16 a[236:237], v14 offset:9216
 v_add3_u32 v4, v4, v34, v35
 v_mfma_f32_16x16x32_bf16 v[100:103], a[244:247], v[28:31], v[100:103]
 ds_read_b64_tr_b16 a[238:239], v14 offset:9728
 s_waitcnt lgkmcnt(8)
 v_mfma_f32_16x16x32_bf16 v[92:95], a[248:251], v[16:19], v[92:95]
 v_xor_b32 v15, 0x10000, v15
 ds_read_b64_tr_b16 a[240:241], v15 offset:0
 v_mfma_f32_16x16x32_bf16 v[92:95], a[252:255], v[24:27], v[92:95]
 ds_read_b64_tr_b16 a[242:243], v15 offset:512
 v_xad_u32 v4, v36, v37, v4
 v_add3_u32 v4, v4, v38, v39
 v_mfma_f32_16x16x32_bf16 v[108:111], a[248:251], v[20:23], v[108:111]
 ds_read_b64_tr_b16 a[244:245], v15 offset:8192
 v_xad_u32 v4, v40, v41, v4
 v_mfma_f32_16x16x32_bf16 v[108:111], a[252:255], v[28:31], v[108:111]
 ds_read_b64_tr_b16 a[246:247], v15 offset:8704
 s_waitcnt lgkmcnt(8)
 v_mfma_f32_16x16x32_bf16 v[112:115], a[224:227], v[16:19], v[112:115]
 ds_read_b64_tr_b16 a[248:249], v15 offset:1024
 v_add3_u32 v4, v4, v42, v43
 v_mfma_f32_16x16x32_bf16 v[112:115], a[228:231], v[24:27], v[112:115]
 ds_read_b64_tr_b16 a[250:251], v15 offset:1536
 v_xad_u32 v4, v44, v45, v4
 v_add3_u32 v4, v4, v46, v47
 v_mfma_f32_16x16x32_bf16 v[128:131], a[224:227], v[20:23], v[128:131]
 ds_read_b64_tr_b16 a[252:253], v15 offset:9216
 v_cmp_ne_u32 vcc, v4, v209
 v_mfma_f32_16x16x32_bf16 v[128:131], a[228:231], v[28:31], v[128:131]
 ds_read_b64_tr_b16 a[254:255], v15 offset:9728
 s_waitcnt lgkmcnt(8)
 v_mfma_f32_16x16x32_bf16 v[120:123], a[232:235], v[16:19], v[120:123]
 ds_read_b64_tr_b16 a[224:225], v12 offset:16384
 buffer_load_dwordx4 v254, s[40:43], s100 offen lds
 v_mfma_f32_16x16x32_bf16 v[120:123], a[236:239], v[24:27], v[120:123]
 ds_read_b64_tr_b16 a[226:227], v12 offset:16896
 ds_read_b64_tr_b16 a[48:49], v8 offset:4096
 ds_read_b64_tr_b16 a[52:53], v255 offset:4096
 v_mfma_f32_16x16x32_bf16 v[136:139], a[232:235], v[20:23], v[136:139]
 ds_read_b64_tr_b16 a[228:229], v12 offset:24576
 s_cbranch_vccnz L_hn5_r
L_hn5_b:
 v_mfma_f32_16x16x32_bf16 v[136:139], a[236:239], v[28:31], v[136:139]
 ds_read_b64_tr_b16 a[230:231], v12 offset:25088
 s_waitcnt lgkmcnt(10)
 v_mfma_f32_16x16x32_bf16 v[116:119], a[240:243], v[16:19], v[116:119]
 ds_read_b64_tr_b16 a[232:233], v12 offset:17408
 ds_read_b64_tr_b16 a[56:57], v253 offset:4096
 v_mfma_f32_16x16x32_bf16 v[116:119], a[244:247], v[24:27], v[116:119]
 ds_read_b64_tr_b16 a[234:235], v12 offset:17920
 ds_read_b64_tr_b16 a[60:61], v251 offset:4096
 s_add_u32 m0, s55, 2048
 v_mfma_f32_16x16x32_bf16 v[132:135], a[240:243], v[20:23], v[132:135]
 ds_read_b64_tr_b16 a[236:237], v12 offset:25600
 s_add_u32 s100, s82, 16384
 v_mfma_f32_16x16x32_bf16 v[132:135], a[244:247], v[28:31], v[132:135]
 ds_read_b64_tr_b16 a[238:239], v12 offset:26112
 s_waitcnt lgkmcnt(12)
 v_mfma_f32_16x16x32_bf16 v[124:127], a[248:251], v[16:19], v[124:127]
 ds_read_b64_tr_b16 a[240:241], v13 offset:16384
 buffer_load_dwordx4 v254, s[40:43], s100 offen lds
 v_mfma_f32_16x16x32_bf16 v[124:127], a[252:255], v[24:27], v[124:127]
 ds_read_b64_tr_b16 a[242:243], v13 offset:16896
 s_add_u32 m0, s55, 3072
 s_add_u32 s100, s82, 24576
 v_mfma_f32_16x16x32_bf16 v[140:143], a[248:251], v[20:23], v[140:143]
 ds_read_b64_tr_b16 a[244:245], v13 offset:24576
 buffer_load_dwordx4 v254, s[40:43], s100 offen lds
 v_mfma_f32_16x16x32_bf16 v[140:143], a[252:255], v[28:31], v[140:143]
 ds_read_b64_tr_b16 a[246:247], v13 offset:25088
 s_waitcnt lgkmcnt(10)
 v_mfma_f32_16x16x32_bf16 v[80:83], a[224:227], v[32:35], v[80:83]
 ds_read_b64_tr_b16 a[248:249], v13 offset:17408
 buffer_load_dwordx4 v[16:19], v223, s[48:51], s8 offen offset:0 sc1
 v_mfma_f32_16x16x32_bf16 v[80:83], a[228:231], v[40:43], v[80:83]
 ds_read_b64_tr_b16 a[250:251], v13 offset:17920
 s_waitcnt vmcnt(14)
 ds_read_b64_tr_b16 a[50:51], v8 offset:6144
 v_mfma_f32_16x16x32_bf16 v[96:99], a[224:227], v[36:39], v[96:99]
 ds_read_b64_tr_b16 a[252:253], v13 offset:25600
 buffer_load_dwordx4 v[20:23], v223, s[48:51], s8 offen offset:256 sc1
 v_mfma_f32_16x16x32_bf16 v[96:99], a[228:231], v[44:47], v[96:99]
 ds_read_b64_tr_b16 a[254:255], v13 offset:26112
 s_waitcnt lgkmcnt(9)
 v_mfma_f32_16x16x32_bf16 v[88:91], a[232:235], v[32:35], v[88:91]
 ds_read_b64_tr_b16 a[224:225], v14 offset:16384
 buffer_load_dwordx4 v[24:27], v223, s[48:51], s8 offen offset:2048 sc1
 v_mfma_f32_16x16x32_bf16 v[88:91], a[236:239], v[40:43], v[88:91]
 ds_read_b64_tr_b16 a[226:227], v14 offset:16896
 ds_read_b64_tr_b16 a[54:55], v255 offset:6144
 s_lshr_b32 s66, s85, 16
 v_mfma_f32_16x16x32_bf16 v[104:107], a[232:235], v[36:39], v[104:107]
 ds_read_b64_tr_b16 a[228:229], v14 offset:24576
 buffer_load_dwordx4 v[28:31], v223, s[48:51], s8 offen offset:2304 sc1
 v_mfma_f32_16x16x32_bf16 v[104:107], a[236:239], v[44:47], v[104:107]
 ds_read_b64_tr_b16 a[230:231], v14 offset:25088
 s_waitcnt lgkmcnt(10)
 v_mfma_f32_16x16x32_bf16 v[84:87], a[240:243], v[32:35], v[84:87]
 ds_read_b64_tr_b16 a[232:233], v14 offset:17408
 s_waitcnt vmcnt(12)
 v_mfma_f32_16x16x32_bf16 v[84:87], a[244:247], v[40:43], v[84:87]
 ds_read_b64_tr_b16 a[234:235], v14 offset:17920
 v_xad_u32 v4, v48, v49, s61
 v_add3_u32 v4, v4, v50, v51
 v_mfma_f32_16x16x32_bf16 v[100:103], a[240:243], v[36:39], v[100:103]
 ds_read_b64_tr_b16 a[236:237], v14 offset:25600
 v_xad_u32 v4, v52, v53, v4
 v_mfma_f32_16x16x32_bf16 v[100:103], a[244:247], v[44:47], v[100:103]
 ds_read_b64_tr_b16 a[238:239], v14 offset:26112
 s_waitcnt lgkmcnt(9)
 v_mfma_f32_16x16x32_bf16 v[92:95], a[248:251], v[32:35], v[92:95]
 ds_read_b64_tr_b16 a[240:241], v15 offset:16384
 v_add3_u32 v4, v4, v54, v55
 v_mfma_f32_16x16x32_bf16 v[92:95], a[252:255], v[40:43], v[92:95]
 ds_read_b64_tr_b16 a[242:243], v15 offset:16896
 v_xad_u32 v4, v56, v57, v4
 v_add3_u32 v4, v4, v58, v59
 v_mfma_f32_16x16x32_bf16 v[108:111], a[248:251], v[36:39], v[108:111]
 ds_read_b64_tr_b16 a[244:245], v15 offset:24576
 v_xad_u32 v4, v60, v61, v4
 v_mfma_f32_16x16x32_bf16 v[108:111], a[252:255], v[44:47], v[108:111]
 ds_read_b64_tr_b16 a[246:247], v15 offset:25088
 s_waitcnt lgkmcnt(8)
 v_mfma_f32_16x16x32_bf16 v[112:115], a[224:227], v[32:35], v[112:115]
 ds_read_b64_tr_b16 a[248:249], v15 offset:17408
 v_add3_u32 v4, v4, v62, v63
 v_mfma_f32_16x16x32_bf16 v[112:115], a[228:231], v[40:43], v[112:115]
 ds_read_b64_tr_b16 a[250:251], v15 offset:17920
 v_cmp_ne_u32 vcc, v4, v210
 ds_read_b64_tr_b16 a[58:59], v253 offset:6144
 v_mfma_f32_16x16x32_bf16 v[128:131], a[224:227], v[36:39], v[128:131]
 ds_read_b64_tr_b16 a[252:253], v15 offset:25600
 ds_read_b64_tr_b16 a[62:63], v251 offset:6144
 v_mfma_f32_16x16x32_bf16 v[128:131], a[228:231], v[44:47], v[128:131]
 ds_read_b64_tr_b16 a[254:255], v15 offset:26112
 s_waitcnt lgkmcnt(10)
 v_mfma_f32_16x16x32_bf16 v[120:123], a[232:235], v[32:35], v[120:123]
 ds_read_b64_tr_b16 a[224:225], v12 offset:32768
 s_add_u32 m0, s55, 4096
 v_mfma_f32_16x16x32_bf16 v[120:123], a[236:239], v[40:43], v[120:123]
 ds_read_b64_tr_b16 a[226:227], v12 offset:33280
 s_cbranch_vccnz L_hn6_r
L_hn6_b:
 v_mfma_f32_16x16x32_bf16 v[136:139], a[232:235], v[36:39], v[136:139]
 ds_read_b64_tr_b16 a[228:229], v12 offset:40960
 s_add_u32 s100, s82, 32768
 v_mfma_f32_16x16x32_bf16 v[136:139], a[236:239], v[44:47], v[136:139]
 ds_read_b64_tr_b16 a[230:231], v12 offset:41472
 s_waitcnt lgkmcnt(10)
 v_mfma_f32_16x16x32_bf16 v[116:119], a[240:243], v[32:35], v[116:119]
 ds_read_b64_tr_b16 a[232:233], v12 offset:33792
 buffer_load_dwordx4 v254, s[40:43], s100 offen lds
 v_mfma_f32_16x16x32_bf16 v[116:119], a[244:247], v[40:43], v[116:119]
 ds_read_b64_tr_b16 a[234:235], v12 offset:34304
 s_add_u32 m0, s55, 5120
 s_mul_i32 s66, s66, 4480
 v_mfma_f32_16x16x32_bf16 v[132:135], a[240:243], v[36:39], v[132:135]
 ds_read_b64_tr_b16 a[236:237], v12 offset:41984
 s_add_u32 s21, s66, s3
 v_mfma_f32_16x16x32_bf16 v[132:135], a[244:247], v[44:47], v[132:135]
 ds_read_b64_tr_b16 a[238:239], v12 offset:42496
 s_waitcnt lgkmcnt(8)
 v_mfma_f32_16x16x32_bf16 v[124:127], a[248:251], v[32:35], v[124:127]
 ds_read_b64_tr_b16 a[240:241], v13 offset:32768
 s_add_u32 s100, s82, 40960
 v_mfma_f32_16x16x32_bf16 v[124:127], a[252:255], v[40:43], v[124:127]
 ds_read_b64_tr_b16 a[242:243], v13 offset:33280
 s_add_u32 s28, s21, 125440
 s_lshr_b32 s66, s86, 16
 v_mfma_f32_16x16x32_bf16 v[140:143], a[248:251], v[36:39], v[140:143]
 ds_read_b64_tr_b16 a[244:245], v13 offset:40960
 s_mul_i32 s66, s66, 4480
 v_mfma_f32_16x16x32_bf16 v[140:143], a[252:255], v[44:47], v[140:143]
 ds_read_b64_tr_b16 a[246:247], v13 offset:41472
 s_waitcnt lgkmcnt(8)
 v_mfma_f32_16x16x32_bf16 v[80:83], a[224:227], v[48:51], v[80:83]
 ds_read_b64_tr_b16 a[248:249], v13 offset:33792
 buffer_load_dwordx4 v[32:35], v223, s[48:51], s9 offen offset:0 sc1
 v_mfma_f32_16x16x32_bf16 v[80:83], a[228:231], v[56:59], v[80:83]
 ds_read_b64_tr_b16 a[250:251], v13 offset:34304
 s_add_u32 s22, s66, s3
 s_add_u32 s29, s22, 125440
 v_mfma_f32_16x16x32_bf16 v[96:99], a[224:227], v[52:55], v[96:99]
 ds_read_b64_tr_b16 a[252:253], v13 offset:41984
 buffer_load_dwordx4 v[36:39], v223, s[48:51], s9 offen offset:256 sc1
 v_mfma_f32_16x16x32_bf16 v[96:99], a[228:231], v[60:63], v[96:99]
 ds_read_b64_tr_b16 a[254:255], v13 offset:42496
 s_waitcnt lgkmcnt(8)
 v_mfma_f32_16x16x32_bf16 v[88:91], a[232:235], v[48:51], v[88:91]
 ds_read_b64_tr_b16 a[224:225], v14 offset:32768
 buffer_load_dwordx4 v[40:43], v223, s[48:51], s9 offen offset:2048 sc1
 v_mfma_f32_16x16x32_bf16 v[88:91], a[236:239], v[56:59], v[88:91]
 ds_read_b64_tr_b16 a[226:227], v14 offset:33280
 s_lshl_b32 s68, s72, 16
 s_add_u32 s68, s68, s74
 v_mfma_f32_16x16x32_bf16 v[104:107], a[232:235], v[52:55], v[104:107]
 ds_read_b64_tr_b16 a[228:229], v14 offset:40960
 buffer_load_dwordx4 v[44:47], v223, s[48:51], s9 offen offset:2304 sc1
 v_mfma_f32_16x16x32_bf16 v[104:107], a[236:239], v[60:63], v[104:107]
 ds_read_b64_tr_b16 a[230:231], v14 offset:41472
 s_waitcnt lgkmcnt(8)
 v_mfma_f32_16x16x32_bf16 v[84:87], a[240:243], v[48:51], v[84:87]
 ds_read_b64_tr_b16 a[232:233], v14 offset:33792
 buffer_load_dwordx4 v254, s[40:43], s100 offen lds
 v_mfma_f32_16x16x32_bf16 v[84:87], a[244:247], v[56:59], v[84:87]
 ds_read_b64_tr_b16 a[234:235], v14 offset:34304
 s_waitcnt vmcnt(12)
 ds_read_b64_tr_b16 a[64:65], v8 offset:0
 v_mfma_f32_16x16x32_bf16 v[100:103], a[240:243], v[52:55], v[100:103]
 ds_read_b64_tr_b16 a[236:237], v14 offset:41984
 ds_read_b64_tr_b16 a[68:69], v255 offset:0
 v_mfma_f32_16x16x32_bf16 v[100:103], a[244:247], v[60:63], v[100:103]
 ds_read_b64_tr_b16 a[238:239], v14 offset:42496
 s_waitcnt lgkmcnt(10)
 v_mfma_f32_16x16x32_bf16 v[92:95], a[248:251], v[48:51], v[92:95]
 ds_read_b64_tr_b16 a[240:241], v15 offset:32768
 ds_read_b64_tr_b16 a[72:73], v253 offset:0
 v_mfma_f32_16x16x32_bf16 v[92:95], a[252:255], v[56:59], v[92:95]
 ds_read_b64_tr_b16 a[242:243], v15 offset:33280
 s_add_u32 s69, s68, 32768
 s_add_u32 s76, s68, 11796480
 v_mfma_f32_16x16x32_bf16 v[108:111], a[248:251], v[52:55], v[108:111]
 ds_read_b64_tr_b16 a[244:245], v15 offset:40960
 ds_read_b64_tr_b16 a[76:77], v251 offset:0
 v_mfma_f32_16x16x32_bf16 v[108:111], a[252:255], v[60:63], v[108:111]
 ds_read_b64_tr_b16 a[246:247], v15 offset:41472
 s_waitcnt lgkmcnt(12)
 v_mfma_f32_16x16x32_bf16 v[112:115], a[224:227], v[48:51], v[112:115]
 ds_read_b64_tr_b16 a[248:249], v15 offset:33792
 s_add_u32 s77, s69, 11796480
 v_mfma_f32_16x16x32_bf16 v[112:115], a[228:231], v[56:59], v[112:115]
 ds_read_b64_tr_b16 a[250:251], v15 offset:34304
 s_add_u32 m0, s55, 6144
 s_lshl_b32 s3, s59, 2
 v_mfma_f32_16x16x32_bf16 v[128:131], a[224:227], v[52:55], v[128:131]
 ds_read_b64_tr_b16 a[252:253], v15 offset:41984
 s_add_u32 s3, s3, s56
 v_mfma_f32_16x16x32_bf16 v[128:131], a[228:231], v[60:63], v[128:131]
 ds_read_b64_tr_b16 a[254:255], v15 offset:42496
 s_waitcnt lgkmcnt(10)
 v_mfma_f32_16x16x32_bf16 v[120:123], a[232:235], v[48:51], v[120:123]
 ds_read_b64_tr_b16 a[224:225], v12 offset:49152
 s_add_u32 s100, s82, 49152
 v_mfma_f32_16x16x32_bf16 v[120:123], a[236:239], v[56:59], v[120:123]
 ds_read_b64_tr_b16 a[226:227], v12 offset:49664
 s_mul_i32 s70, s3, 56
 s_add_u32 s70, s70, s60
 v_mfma_f32_16x16x32_bf16 v[136:139], a[232:235], v[52:55], v[136:139]
 ds_read_b64_tr_b16 a[228:229], v12 offset:57344
 s_mul_i32 s70, s70, 4480
 v_mfma_f32_16x16x32_bf16 v[136:139], a[236:239], v[60:63], v[136:139]
 ds_read_b64_tr_b16 a[230:231], v12 offset:57856
 s_waitcnt lgkmcnt(8)
 v_mfma_f32_16x16x32_bf16 v[116:119], a[240:243], v[48:51], v[116:119]
 ds_read_b64_tr_b16 a[232:233], v12 offset:50176
 buffer_load_dwordx4 v254, s[40:43], s100 offen lds
 v_mfma_f32_16x16x32_bf16 v[116:119], a[244:247], v[56:59], v[116:119]
 ds_read_b64_tr_b16 a[234:235], v12 offset:50688
 s_add_u32 s70, s70, 13893632
 s_add_u32 s71, s70, 125440
 v_mfma_f32_16x16x32_bf16 v[132:135], a[240:243], v[52:55], v[132:135]
 ds_read_b64_tr_b16 a[236:237], v12 offset:58368
 s_lshl_b32 s58, s72, 3
 v_mfma_f32_16x16x32_bf16 v[132:135], a[244:247], v[60:63], v[132:135]
 ds_read_b64_tr_b16 a[238:239], v12 offset:58880
 s_waitcnt lgkmcnt(8)
 v_mfma_f32_16x16x32_bf16 v[124:127], a[248:251], v[48:51], v[124:127]
 ds_read_b64_tr_b16 a[240:241], v13 offset:49152
 s_add_u32 m0, s55, 7168
 v_mfma_f32_16x16x32_bf16 v[124:127], a[252:255], v[56:59], v[124:127]
 ds_read_b64_tr_b16 a[242:243], v13 offset:49664
 s_add_u32 s58, s58, s56
 s_mul_i32 s95, s58, 31360
 v_mfma_f32_16x16x32_bf16 v[140:143], a[248:251], v[52:55], v[140:143]
 ds_read_b64_tr_b16 a[244:245], v13 offset:57344
 s_add_u32 s100, s82, 57344
 v_mfma_f32_16x16x32_bf16 v[140:143], a[252:255], v[60:63], v[140:143]
 ds_read_b64_tr_b16 a[246:247], v13 offset:57856
 s_waitcnt lgkmcnt(8)
 v_mfma_f32_16x16x32_bf16 v[80:83], a[224:227], v[64:67], v[80:83]
 ds_read_b64_tr_b16 a[248:249], v13 offset:50176
 buffer_load_dwordx4 v[48:51], v223, s[48:51], s10 offen offset:0 sc1
 v_mfma_f32_16x16x32_bf16 v[80:83], a[228:231], v[72:75], v[80:83]
 ds_read_b64_tr_b16 a[250:251], v13 offset:50688
 s_add_u32 s95, s95, 13897984
 s_add_u32 s78, s95, 125440
 v_mfma_f32_16x16x32_bf16 v[96:99], a[224:227], v[68:71], v[96:99]
 ds_read_b64_tr_b16 a[252:253], v13 offset:58368
 buffer_load_dwordx4 v[52:55], v223, s[48:51], s10 offen offset:256 sc1
 v_mfma_f32_16x16x32_bf16 v[96:99], a[228:231], v[76:79], v[96:99]
 ds_read_b64_tr_b16 a[254:255], v13 offset:58880
 s_waitcnt lgkmcnt(8)
 v_mfma_f32_16x16x32_bf16 v[88:91], a[232:235], v[64:67], v[88:91]
 ds_read_b64_tr_b16 a[224:225], v14 offset:49152
 buffer_load_dwordx4 v[56:59], v223, s[48:51], s10 offen offset:2048 sc1
 v_mfma_f32_16x16x32_bf16 v[88:91], a[236:239], v[72:75], v[88:91]
 ds_read_b64_tr_b16 a[226:227], v14 offset:49664
 s_lshl_b32 s58, s58, 2
 s_lshr_b32 s3, s74, 8
 v_mfma_f32_16x16x32_bf16 v[104:107], a[232:235], v[68:71], v[104:107]
 ds_read_b64_tr_b16 a[228:229], v14 offset:57344
 buffer_load_dwordx4 v[60:63], v223, s[48:51], s10 offen offset:2304 sc1
 v_mfma_f32_16x16x32_bf16 v[104:107], a[236:239], v[76:79], v[104:107]
 ds_read_b64_tr_b16 a[230:231], v14 offset:57856
 s_waitcnt lgkmcnt(8)
 v_mfma_f32_16x16x32_bf16 v[84:87], a[240:243], v[64:67], v[84:87]
 ds_read_b64_tr_b16 a[232:233], v14 offset:50176
 buffer_load_dwordx4 v254, s[40:43], s100 offen lds
 v_mfma_f32_16x16x32_bf16 v[84:87], a[244:247], v[72:75], v[84:87]
 ds_read_b64_tr_b16 a[234:235], v14 offset:50688
 s_waitcnt vmcnt(16)
 ds_read_b64_tr_b16 a[66:67], v8 offset:2048
 v_mfma_f32_16x16x32_bf16 v[100:103], a[240:243], v[68:71], v[100:103]
 ds_read_b64_tr_b16 a[236:237], v14 offset:58368
 s_add_u32 s58, s58, s3
 v_mfma_f32_16x16x32_bf16 v[100:103], a[244:247], v[76:79], v[100:103]
 ds_read_b64_tr_b16 a[238:239], v14 offset:58880
 s_waitcnt lgkmcnt(9)
 v_mfma_f32_16x16x32_bf16 v[92:95], a[248:251], v[64:67], v[92:95]
 ds_read_b64_tr_b16 a[240:241], v15 offset:49152
 ds_read_b64_tr_b16 a[70:71], v255 offset:2048
 v_mfma_f32_16x16x32_bf16 v[92:95], a[252:255], v[72:75], v[92:95]
 ds_read_b64_tr_b16 a[242:243], v15 offset:49664
 s_lshl_b32 s58, s58, 7
 s_add_u32 s58, s58, 786432
 v_mfma_f32_16x16x32_bf16 v[108:111], a[248:251], v[68:71], v[108:111]
 ds_read_b64_tr_b16 a[244:245], v15 offset:57344
 ds_read_b64_tr_b16 a[74:75], v253 offset:2048
 v_mfma_f32_16x16x32_bf16 v[108:111], a[252:255], v[76:79], v[108:111]
 ds_read_b64_tr_b16 a[246:247], v15 offset:57856
 s_waitcnt lgkmcnt(11)
 v_mfma_f32_16x16x32_bf16 v[112:115], a[224:227], v[64:67], v[112:115]
 ds_read_b64_tr_b16 a[248:249], v15 offset:50176
 s_lshl_b32 s54, s56, 15
 v_mfma_f32_16x16x32_bf16 v[112:115], a[228:231], v[72:75], v[112:115]
 ds_read_b64_tr_b16 a[250:251], v15 offset:50688
 ds_read_b64_tr_b16 a[78:79], v251 offset:2048
 s_mov_b32 s46, 2097152
 v_mfma_f32_16x16x32_bf16 v[128:131], a[224:227], v[68:71], v[128:131]
 ds_read_b64_tr_b16 a[252:253], v15 offset:58368
 s_mov_b32 s47, 0x20000
 v_mfma_f32_16x16x32_bf16 v[128:131], a[228:231], v[76:79], v[128:131]
 ds_read_b64_tr_b16 a[254:255], v15 offset:58880
 s_waitcnt lgkmcnt(11)
 v_mfma_f32_16x16x32_bf16 v[120:123], a[232:235], v[64:67], v[120:123]
 v_xor_b32 v12, 0x10000, v12
 ds_read_b64_tr_b16 a[224:225], v12 offset:0
 v_mfma_f32_16x16x32_bf16 v[120:123], a[236:239], v[72:75], v[120:123]
 ds_read_b64_tr_b16 a[226:227], v12 offset:512
 s_add_u32 m0, s55, 0
 v_mfma_f32_16x16x32_bf16 v[136:139], a[232:235], v[68:71], v[136:139]
 ds_read_b64_tr_b16 a[228:229], v12 offset:8192
 v_mfma_f32_16x16x32_bf16 v[136:139], a[236:239], v[76:79], v[136:139]
 ds_read_b64_tr_b16 a[230:231], v12 offset:8704
 s_waitcnt lgkmcnt(9)
 v_mfma_f32_16x16x32_bf16 v[116:119], a[240:243], v[64:67], v[116:119]
 ds_read_b64_tr_b16 a[232:233], v12 offset:1024
 buffer_load_dwordx4 v254, s[40:43], s83 offen lds
 v_mfma_f32_16x16x32_bf16 v[116:119], a[244:247], v[72:75], v[116:119]
 ds_read_b64_tr_b16 a[234:235], v12 offset:1536
 v_mfma_f32_16x16x32_bf16 v[132:135], a[240:243], v[68:71], v[132:135]
 ds_read_b64_tr_b16 a[236:237], v12 offset:9216
 v_mfma_f32_16x16x32_bf16 v[132:135], a[244:247], v[76:79], v[132:135]
 ds_read_b64_tr_b16 a[238:239], v12 offset:9728
 s_waitcnt lgkmcnt(8)
 v_mfma_f32_16x16x32_bf16 v[124:127], a[248:251], v[64:67], v[124:127]
 v_xor_b32 v13, 0x10000, v13
 ds_read_b64_tr_b16 a[240:241], v13 offset:0
 v_mfma_f32_16x16x32_bf16 v[124:127], a[252:255], v[72:75], v[124:127]
 ds_read_b64_tr_b16 a[242:243], v13 offset:512
 s_waitcnt vmcnt(13)
 s_add_u32 m0, s55, 1024
 v_mfma_f32_16x16x32_bf16 v[140:143], a[248:251], v[68:71], v[140:143]
 ds_read_b64_tr_b16 a[244:245], v13 offset:8192
 s_add_u32 s100, s83, 8192
 v_mfma_f32_16x16x32_bf16 v[140:143], a[252:255], v[76:79], v[140:143]
 ds_read_b64_tr_b16 a[246:247], v13 offset:8704
 buffer_load_dwordx4 v[64:67], v223, s[48:51], s11 offen offset:0 sc1
 buffer_load_dwordx4 v[68:71], v223, s[48:51], s11 offen offset:256 sc1
 buffer_load_dwordx4 v[72:75], v223, s[48:51], s11 offen offset:2048 sc1
 buffer_load_dwordx4 v[76:79], v223, s[48:51], s11 offen offset:2304 sc1
 s_mov_b32 s4, 0xbfb8aa3b
 s_mov_b32 s5, 0xbfb8aa3b
 v_pk_mul_f32 v[240:241], v[80:81], s[4:5]
 v_pk_mul_f32 v[242:243], v[82:83], s[4:5]
 v_pk_mul_f32 v[244:245], v[84:85], s[4:5]
 v_pk_mul_f32 v[246:247], v[86:87], s[4:5]
 v_exp_f32 v240, v240
 v_exp_f32 v241, v241
 v_exp_f32 v242, v242
 v_exp_f32 v243, v243
 v_exp_f32 v244, v244
 v_exp_f32 v245, v245
 v_exp_f32 v246, v246
 v_exp_f32 v247, v247
 v_pk_add_f32 v[240:241], v[240:241], 1.0 op_sel_hi:[1,0]
 v_pk_add_f32 v[242:243], v[242:243], 1.0 op_sel_hi:[1,0]
 v_pk_add_f32 v[244:245], v[244:245], 1.0 op_sel_hi:[1,0]
 v_pk_add_f32 v[246:247], v[246:247], 1.0 op_sel_hi:[1,0]
 v_rcp_f32 v240, v240
 v_rcp_f32 v241, v241
 v_rcp_f32 v242, v242
 v_rcp_f32 v243, v243
 v_rcp_f32 v244, v244
 v_rcp_f32 v245, v245
 v_rcp_f32 v246, v246
 v_rcp_f32 v247, v247
 v_pk_mul_f32 v[240:241], v[240:241], v[88:89]
 v_pk_mul_f32 v[242:243], v[242:243], v[90:91]
 v_pk_mul_f32 v[244:245], v[244:245], v[92:93]
 v_pk_mul_f32 v[246:247], v[246:247], v[94:95]
 v_cvt_pk_bf16_f32 v80, v240, v241
 v_cvt_pk_bf16_f32 v81, v242, v243
 v_cvt_pk_bf16_f32 v82, v244, v245
 v_cvt_pk_bf16_f32 v83, v246, v247
 buffer_store_dwordx4 v[80:83], v6, s[48:51], s70 offen offset:0 sc1
 v_xad_u32 v222, v80, v81, s61
 v_add3_u32 v222, v222, v82, v83
 v_pk_mul_f32 v[240:241], v[96:97], s[4:5]
 v_pk_mul_f32 v[242:243], v[98:99], s[4:5]
 v_pk_mul_f32 v[244:245], v[100:101], s[4:5]
 v_pk_mul_f32 v[246:247], v[102:103], s[4:5]
 v_exp_f32 v240, v240
 v_exp_f32 v241, v241
 v_exp_f32 v242, v242
 v_exp_f32 v243, v243
 v_exp_f32 v244, v244
 v_exp_f32 v245, v245
 v_exp_f32 v246, v246
 v_exp_f32 v247, v247
 v_pk_add_f32 v[240:241], v[240:241], 1.0 op_sel_hi:[1,0]
 v_pk_add_f32 v[242:243], v[242:243], 1.0 op_sel_hi:[1,0]
 v_pk_add_f32 v[244:245], v[244:245], 1.0 op_sel_hi:[1,0]
 v_pk_add_f32 v[246:247], v[246:247], 1.0 op_sel_hi:[1,0]
 v_rcp_f32 v240, v240
 v_rcp_f32 v241, v241
 v_rcp_f32 v242, v242
 v_rcp_f32 v243, v243
 v_rcp_f32 v244, v244
 v_rcp_f32 v245, v245
 v_rcp_f32 v246, v246
 v_rcp_f32 v247, v247
 v_pk_mul_f32 v[240:241], v[240:241], v[104:105]
 v_pk_mul_f32 v[242:243], v[242:243], v[106:107]
 v_pk_mul_f32 v[244:245], v[244:245], v[108:109]
 v_pk_mul_f32 v[246:247], v[246:247], v[110:111]
 v_cvt_pk_bf16_f32 v96, v240, v241
 v_cvt_pk_bf16_f32 v97, v242, v243
 v_cvt_pk_bf16_f32 v98, v244, v245
 v_cvt_pk_bf16_f32 v99, v246, v247
 buffer_store_dwordx4 v[96:99], v6, s[48:51], s70 offen offset:1024 sc1
 v_xad_u32 v222, v96, v97, v222
 v_add3_u32 v222, v222, v98, v99
 v_pk_mul_f32 v[240:241], v[112:113], s[4:5]
 v_pk_mul_f32 v[242:243], v[114:115], s[4:5]
 v_pk_mul_f32 v[244:245], v[116:117], s[4:5]
 v_pk_mul_f32 v[246:247], v[118:119], s[4:5]
 v_exp_f32 v240, v240
 v_exp_f32 v241, v241
 v_exp_f32 v242, v242
 v_exp_f32 v243, v243
 v_exp_f32 v244, v244
 v_exp_f32 v245, v245
 v_exp_f32 v246, v246
 v_exp_f32 v247, v247
 v_pk_add_f32 v[240:241], v[240:241], 1.0 op_sel_hi:[1,0]
 v_pk_add_f32 v[242:243], v[242:243], 1.0 op_sel_hi:[1,0]
 v_pk_add_f32 v[244:245], v[244:245], 1.0 op_sel_hi:[1,0]
 v_pk_add_f32 v[246:247], v[246:247], 1.0 op_sel_hi:[1,0]
 v_rcp_f32 v240, v240
 v_rcp_f32 v241, v241
 v_rcp_f32 v242, v242
 v_rcp_f32 v243, v243
 v_rcp_f32 v244, v244
 v_rcp_f32 v245, v245
 v_rcp_f32 v246, v246
 v_rcp_f32 v247, v247
 v_pk_mul_f32 v[240:241], v[240:241], v[120:121]
 v_pk_mul_f32 v[242:243], v[242:243], v[122:123]
 v_pk_mul_f32 v[244:245], v[244:245], v[124:125]
 v_pk_mul_f32 v[246:247], v[246:247], v[126:127]
 v_cvt_pk_bf16_f32 v112, v240, v241
 v_cvt_pk_bf16_f32 v113, v242, v243
 v_cvt_pk_bf16_f32 v114, v244, v245
 v_cvt_pk_bf16_f32 v115, v246, v247
 buffer_store_dwordx4 v[112:115], v6, s[48:51], s70 offen offset:2048 sc1
 v_xad_u32 v222, v112, v113, v222
 v_add3_u32 v222, v222, v114, v115
 v_pk_mul_f32 v[240:241], v[128:129], s[4:5]
 v_pk_mul_f32 v[242:243], v[130:131], s[4:5]
 v_pk_mul_f32 v[244:245], v[132:133], s[4:5]
 v_pk_mul_f32 v[246:247], v[134:135], s[4:5]
 v_exp_f32 v240, v240
 v_exp_f32 v241, v241
 v_exp_f32 v242, v242
 v_exp_f32 v243, v243
 v_exp_f32 v244, v244
 v_exp_f32 v245, v245
 v_exp_f32 v246, v246
 v_exp_f32 v247, v247
 v_pk_add_f32 v[240:241], v[240:241], 1.0 op_sel_hi:[1,0]
 v_pk_add_f32 v[242:243], v[242:243], 1.0 op_sel_hi:[1,0]
 v_pk_add_f32 v[244:245], v[244:245], 1.0 op_sel_hi:[1,0]
 v_pk_add_f32 v[246:247], v[246:247], 1.0 op_sel_hi:[1,0]
 v_rcp_f32 v240, v240
 v_rcp_f32 v241, v241
 v_rcp_f32 v242, v242
 v_rcp_f32 v243, v243
 v_rcp_f32 v244, v244
 v_rcp_f32 v245, v245
 v_rcp_f32 v246, v246
 v_rcp_f32 v247, v247
 v_pk_mul_f32 v[240:241], v[240:241], v[136:137]
 v_pk_mul_f32 v[242:243], v[242:243], v[138:139]
 v_pk_mul_f32 v[244:245], v[244:245], v[140:141]
 v_pk_mul_f32 v[246:247], v[246:247], v[142:143]
 v_cvt_pk_bf16_f32 v128, v240, v241
 v_cvt_pk_bf16_f32 v129, v242, v243
 v_cvt_pk_bf16_f32 v130, v244, v245
 v_cvt_pk_bf16_f32 v131, v246, v247
 buffer_store_dwordx4 v[128:131], v6, s[48:51], s70 offen offset:3072 sc1
 v_xad_u32 v222, v128, v129, v222
 v_add3_u32 v222, v222, v130, v131
 buffer_store_dword v222, v2, s[48:51], s70 offen sc1
 buffer_store_dword v10, v7, s[48:51], s70 offen sc1
 s_waitcnt lgkmcnt(8)
 v_mfma_f32_16x16x32_bf16 v[144:147], a[224:227], v[16:19], 0
 ds_read_b64_tr_b16 a[248:249], v13 offset:1024
 v_mfma_f32_16x16x32_bf16 v[144:147], a[228:231], v[24:27], v[144:147]
 ds_read_b64_tr_b16 a[250:251], v13 offset:1536
 v_mfma_f32_16x16x32_bf16 v[160:163], a[224:227], v[20:23], 0
 ds_read_b64_tr_b16 a[252:253], v13 offset:9216
 buffer_load_dwordx4 v254, s[40:43], s100 offen lds
 v_mfma_f32_16x16x32_bf16 v[160:163], a[228:231], v[28:31], v[160:163]
 ds_read_b64_tr_b16 a[254:255], v13 offset:9728
 s_waitcnt lgkmcnt(8)
 v_mfma_f32_16x16x32_bf16 v[152:155], a[232:235], v[16:19], 0
 v_xor_b32 v14, 0x10000, v14
 ds_read_b64_tr_b16 a[224:225], v14 offset:0
 v_mfma_f32_16x16x32_bf16 v[152:155], a[236:239], v[24:27], v[152:155]
 ds_read_b64_tr_b16 a[226:227], v14 offset:512
 s_waitcnt vmcnt(18)
 v_mfma_f32_16x16x32_bf16 v[168:171], a[232:235], v[20:23], 0
 ds_read_b64_tr_b16 a[228:229], v14 offset:8192
 ds_read_b64_tr_b16 a[80:81], v8 offset:4096
 v_mfma_f32_16x16x32_bf16 v[168:171], a[236:239], v[28:31], v[168:171]
 ds_read_b64_tr_b16 a[230:231], v14 offset:8704
 s_waitcnt lgkmcnt(9)
 v_mfma_f32_16x16x32_bf16 v[148:151], a[240:243], v[16:19], 0
 ds_read_b64_tr_b16 a[232:233], v14 offset:1024
 ds_read_b64_tr_b16 a[84:85], v255 offset:4096
 v_mfma_f32_16x16x32_bf16 v[148:151], a[244:247], v[24:27], v[148:151]
 ds_read_b64_tr_b16 a[234:235], v14 offset:1536
 v_mfma_f32_16x16x32_bf16 v[164:167], a[240:243], v[20:23], 0
 ds_read_b64_tr_b16 a[236:237], v14 offset:9216
 ds_read_b64_tr_b16 a[88:89], v253 offset:4096
 v_mfma_f32_16x16x32_bf16 v[164:167], a[244:247], v[28:31], v[164:167]
 ds_read_b64_tr_b16 a[238:239], v14 offset:9728
 s_waitcnt lgkmcnt(11)
 v_mfma_f32_16x16x32_bf16 v[156:159], a[248:251], v[16:19], 0
 v_xor_b32 v15, 0x10000, v15
 ds_read_b64_tr_b16 a[240:241], v15 offset:0
 v_mfma_f32_16x16x32_bf16 v[156:159], a[252:255], v[24:27], v[156:159]
 ds_read_b64_tr_b16 a[242:243], v15 offset:512
 ds_read_b64_tr_b16 a[92:93], v251 offset:4096
 v_mfma_f32_16x16x32_bf16 v[172:175], a[248:251], v[20:23], 0
 ds_read_b64_tr_b16 a[244:245], v15 offset:8192
 s_add_u32 m0, s55, 2048
 v_mfma_f32_16x16x32_bf16 v[172:175], a[252:255], v[28:31], v[172:175]
 ds_read_b64_tr_b16 a[246:247], v15 offset:8704
 s_waitcnt lgkmcnt(11)
 v_mfma_f32_16x16x32_bf16 v[176:179], a[224:227], v[16:19], 0
 ds_read_b64_tr_b16 a[248:249], v15 offset:1024
 s_add_u32 s100, s83, 16384
 v_mfma_f32_16x16x32_bf16 v[176:179], a[228:231], v[24:27], v[176:179]
 ds_read_b64_tr_b16 a[250:251], v15 offset:1536
 v_mfma_f32_16x16x32_bf16 v[192:195], a[224:227], v[20:23], 0
 ds_read_b64_tr_b16 a[252:253], v15 offset:9216
 v_mfma_f32_16x16x32_bf16 v[192:195], a[228:231], v[28:31], v[192:195]
 ds_read_b64_tr_b16 a[254:255], v15 offset:9728
 s_waitcnt lgkmcnt(9)
 v_mfma_f32_16x16x32_bf16 v[184:187], a[232:235], v[16:19], 0
 ds_read_b64_tr_b16 a[224:225], v12 offset:16384
 buffer_load_dwordx4 v254, s[40:43], s100 offen lds
 v_mfma_f32_16x16x32_bf16 v[184:187], a[236:239], v[24:27], v[184:187]
 ds_read_b64_tr_b16 a[226:227], v12 offset:16896
 s_add_u32 m0, s55, 3072
 v_mfma_f32_16x16x32_bf16 v[200:203], a[232:235], v[20:23], 0
 ds_read_b64_tr_b16 a[228:229], v12 offset:24576
 v_mfma_f32_16x16x32_bf16 v[200:203], a[236:239], v[28:31], v[200:203]
 ds_read_b64_tr_b16 a[230:231], v12 offset:25088
 s_waitcnt lgkmcnt(8)
 v_mfma_f32_16x16x32_bf16 v[180:183], a[240:243], v[16:19], 0
 ds_read_b64_tr_b16 a[232:233], v12 offset:17408
 s_add_u32 s100, s83, 24576
 v_mfma_f32_16x16x32_bf16 v[180:183], a[244:247], v[24:27], v[180:183]
 ds_read_b64_tr_b16 a[234:235], v12 offset:17920
 buffer_load_dwordx4 v254, s[40:43], s100 offen lds
 v_mfma_f32_16x16x32_bf16 v[196:199], a[240:243], v[20:23], 0
 ds_read_b64_tr_b16 a[236:237], v12 offset:25600
 v_mfma_f32_16x16x32_bf16 v[196:199], a[244:247], v[28:31], v[196:199]
 ds_read_b64_tr_b16 a[238:239], v12 offset:26112
 s_waitcnt lgkmcnt(8)
 v_mfma_f32_16x16x32_bf16 v[188:191], a[248:251], v[16:19], 0
 ds_read_b64_tr_b16 a[240:241], v13 offset:16384
 s_waitcnt vmcnt(14)
 v_mfma_f32_16x16x32_bf16 v[188:191], a[252:255], v[24:27], v[188:191]
 ds_read_b64_tr_b16 a[242:243], v13 offset:16896
 v_mfma_f32_16x16x32_bf16 v[204:207], a[248:251], v[20:23], 0
 ds_read_b64_tr_b16 a[244:245], v13 offset:24576
 ds_read_b64_tr_b16 a[82:83], v8 offset:6144
 v_mfma_f32_16x16x32_bf16 v[204:207], a[252:255], v[28:31], v[204:207]
 ds_read_b64_tr_b16 a[246:247], v13 offset:25088
 s_waitcnt lgkmcnt(9)
 v_mfma_f32_16x16x32_bf16 v[144:147], a[224:227], v[32:35], v[144:147]
 ds_read_b64_tr_b16 a[248:249], v13 offset:17408
 buffer_load_dwordx4 v[16:19], v223, s[48:51], s12 offen offset:0 sc1
 v_mfma_f32_16x16x32_bf16 v[144:147], a[228:231], v[40:43], v[144:147]
 ds_read_b64_tr_b16 a[250:251], v13 offset:17920
 ds_read_b64_tr_b16 a[86:87], v255 offset:6144
 v_mfma_f32_16x16x32_bf16 v[160:163], a[224:227], v[36:39], v[160:163]
 ds_read_b64_tr_b16 a[252:253], v13 offset:25600
 buffer_load_dwordx4 v[20:23], v223, s[48:51], s12 offen offset:256 sc1
 v_mfma_f32_16x16x32_bf16 v[160:163], a[228:231], v[44:47], v[160:163]
 ds_read_b64_tr_b16 a[254:255], v13 offset:26112
 s_waitcnt lgkmcnt(10)
 v_mfma_f32_16x16x32_bf16 v[152:155], a[232:235], v[32:35], v[152:155]
 ds_read_b64_tr_b16 a[224:225], v14 offset:16384
 buffer_load_dwordx4 v[24:27], v223, s[48:51], s12 offen offset:2048 sc1
 v_mfma_f32_16x16x32_bf16 v[152:155], a[236:239], v[40:43], v[152:155]
 ds_read_b64_tr_b16 a[226:227], v14 offset:16896
 ds_read_b64_tr_b16 a[90:91], v253 offset:6144
 v_mfma_f32_16x16x32_bf16 v[168:171], a[232:235], v[36:39], v[168:171]
 ds_read_b64_tr_b16 a[228:229], v14 offset:24576
 buffer_load_dwordx4 v[28:31], v223, s[48:51], s12 offen offset:2304 sc1
 v_mfma_f32_16x16x32_bf16 v[168:171], a[236:239], v[44:47], v[168:171]
 ds_read_b64_tr_b16 a[230:231], v14 offset:25088
 s_waitcnt lgkmcnt(10)
 v_mfma_f32_16x16x32_bf16 v[148:151], a[240:243], v[32:35], v[148:151]
 ds_read_b64_tr_b16 a[232:233], v14 offset:17408
 ds_read_b64_tr_b16 a[94:95], v251 offset:6144
 v_mfma_f32_16x16x32_bf16 v[148:151], a[244:247], v[40:43], v[148:151]
 ds_read_b64_tr_b16 a[234:235], v14 offset:17920
 s_add_u32 m0, s55, 4096
 v_mfma_f32_16x16x32_bf16 v[164:167], a[240:243], v[36:39], v[164:167]
 ds_read_b64_tr_b16 a[236:237], v14 offset:25600
 s_add_u32 s100, s83, 32768
 v_mfma_f32_16x16x32_bf16 v[164:167], a[244:247], v[44:47], v[164:167]
 ds_read_b64_tr_b16 a[238:239], v14 offset:26112
 s_waitcnt lgkmcnt(10)
 v_mfma_f32_16x16x32_bf16 v[156:159], a[248:251], v[32:35], v[156:159]
 ds_read_b64_tr_b16 a[240:241], v15 offset:16384
 buffer_load_dwordx4 v254, s[40:43], s100 offen lds
 v_mfma_f32_16x16x32_bf16 v[156:159], a[252:255], v[40:43], v[156:159]
 ds_read_b64_tr_b16 a[242:243], v15 offset:16896
 s_add_u32 m0, s55, 5120
 v_mfma_f32_16x16x32_bf16 v[172:175], a[248:251], v[36:39], v[172:175]
 ds_read_b64_tr_b16 a[244:245], v15 offset:24576
 v_mfma_f32_16x16x32_bf16 v[172:175], a[252:255], v[44:47], v[172:175]
 ds_read_b64_tr_b16 a[246:247], v15 offset:25088
 s_waitcnt lgkmcnt(9)
 v_mfma_f32_16x16x32_bf16 v[176:179], a[224:227], v[32:35], v[176:179]
 ds_read_b64_tr_b16 a[248:249], v15 offset:17408
 v_lshrrev_b32 v1, 5, v6
 v_mfma_f32_16x16x32_bf16 v[176:179], a[228:231], v[40:43], v[176:179]
 ds_read_b64_tr_b16 a[250:251], v15 offset:17920
 v_lshlrev_b32 v1, 25, v1
 v_mfma_f32_16x16x32_bf16 v[192:195], a[224:227], v[36:39], v[192:195]
 ds_read_b64_tr_b16 a[252:253], v15 offset:25600
 v_lshl_add_u32 v1, v6, 7, v1
 v_mfma_f32_16x16x32_bf16 v[192:195], a[228:231], v[44:47], v[192:195]
 ds_read_b64_tr_b16 a[254:255], v15 offset:26112
 s_waitcnt lgkmcnt(8)
 v_mfma_f32_16x16x32_bf16 v[184:187], a[232:235], v[32:35], v[184:187]
 ds_read_b64_tr_b16 a[224:225], v12 offset:32768
 buffer_load_dword v3, v1, s[48:51], s58 offen sc1
 v_mfma_f32_16x16x32_bf16 v[184:187], a[236:239], v[40:43], v[184:187]
 ds_read_b64_tr_b16 a[226:227], v12 offset:33280
 s_add_u32 s100, s83, 40960
 v_mfma_f32_16x16x32_bf16 v[200:203], a[232:235], v[36:39], v[200:203]
 ds_read_b64_tr_b16 a[228:229], v12 offset:40960
 buffer_load_dwordx4 v254, s[40:43], s100 offen lds
 v_mfma_f32_16x16x32_bf16 v[200:203], a[236:239], v[44:47], v[200:203]
 ds_read_b64_tr_b16 a[230:231], v12 offset:41472
 s_waitcnt lgkmcnt(8)
 v_mfma_f32_16x16x32_bf16 v[180:183], a[240:243], v[32:35], v[180:183]
 ds_read_b64_tr_b16 a[232:233], v12 offset:33792
 s_waitcnt vmcnt(9)
 v_mfma_f32_16x16x32_bf16 v[180:183], a[244:247], v[40:43], v[180:183]
 ds_read_b64_tr_b16 a[234:235], v12 offset:34304
 ds_read_b64_tr_b16 a[96:97], v8 offset:0
 v_mfma_f32_16x16x32_bf16 v[196:199], a[240:243], v[36:39], v[196:199]
 ds_read_b64_tr_b16 a[236:237], v12 offset:41984
 ds_read_b64_tr_b16 a[100:101], v255 offset:0
 v_mfma_f32_16x16x32_bf16 v[196:199], a[244:247], v[44:47], v[196:199]
 ds_read_b64_tr_b16 a[238:239], v12 offset:42496
 s_waitcnt lgkmcnt(10)
 v_mfma_f32_16x16x32_bf16 v[188:191], a[248:251], v[32:35], v[188:191]
 ds_read_b64_tr_b16 a[240:241], v13 offset:32768
 ds_read_b64_tr_b16 a[104:105], v253 offset:0
 v_mfma_f32_16x16x32_bf16 v[188:191], a[252:255], v[40:43], v[188:191]
 ds_read_b64_tr_b16 a[242:243], v13 offset:33280
 ds_read_b64_tr_b16 a[108:109], v251 offset:0
 v_mfma_f32_16x16x32_bf16 v[204:207], a[248:251], v[36:39], v[204:207]
 ds_read_b64_tr_b16 a[244:245], v13 offset:40960
 v_mfma_f32_16x16x32_bf16 v[204:207], a[252:255], v[44:47], v[204:207]
 ds_read_b64_tr_b16 a[246:247], v13 offset:41472
 s_waitcnt lgkmcnt(12)
 v_mfma_f32_16x16x32_bf16 v[144:147], a[224:227], v[48:51], v[144:147]
 ds_read_b64_tr_b16 a[248:249], v13 offset:33792
 buffer_load_dwordx4 v[32:35], v223, s[48:51], s13 offen offset:0 sc1
 v_mfma_f32_16x16x32_bf16 v[144:147], a[228:231], v[56:59], v[144:147]
 ds_read_b64_tr_b16 a[250:251], v13 offset:34304
 s_add_u32 m0, s55, 6144
 v_mfma_f32_16x16x32_bf16 v[160:163], a[224:227], v[52:55], v[160:163]
 ds_read_b64_tr_b16 a[252:253], v13 offset:41984
 buffer_load_dwordx4 v[36:39], v223, s[48:51], s13 offen offset:256 sc1
 v_mfma_f32_16x16x32_bf16 v[160:163], a[228:231], v[60:63], v[160:163]
 ds_read_b64_tr_b16 a[254:255], v13 offset:42496
 s_waitcnt lgkmcnt(10)
 v_mfma_f32_16x16x32_bf16 v[152:155], a[232:235], v[48:51], v[152:155]
 ds_read_b64_tr_b16 a[224:225], v14 offset:32768
 buffer_load_dwordx4 v[40:43], v223, s[48:51], s13 offen offset:2048 sc1
 v_mfma_f32_16x16x32_bf16 v[152:155], a[236:239], v[56:59], v[152:155]
 ds_read_b64_tr_b16 a[226:227], v14 offset:33280
 s_add_u32 s100, s83, 49152
 v_mfma_f32_16x16x32_bf16 v[168:171], a[232:235], v[52:55], v[168:171]
 ds_read_b64_tr_b16 a[228:229], v14 offset:40960
 buffer_load_dwordx4 v[44:47], v223, s[48:51], s13 offen offset:2304 sc1
 v_mfma_f32_16x16x32_bf16 v[168:171], a[236:239], v[60:63], v[168:171]
 ds_read_b64_tr_b16 a[230:231], v14 offset:41472
 s_waitcnt lgkmcnt(8)
 v_mfma_f32_16x16x32_bf16 v[148:151], a[240:243], v[48:51], v[148:151]
 ds_read_b64_tr_b16 a[232:233], v14 offset:33792
 buffer_load_dwordx4 v254, s[40:43], s100 offen lds
 v_mfma_f32_16x16x32_bf16 v[148:151], a[244:247], v[56:59], v[148:151]
 ds_read_b64_tr_b16 a[234:235], v14 offset:34304
 s_add_u32 m0, s55, 7168
 v_mfma_f32_16x16x32_bf16 v[164:167], a[240:243], v[52:55], v[164:167]
 ds_read_b64_tr_b16 a[236:237], v14 offset:41984
 s_add_u32 s100, s83, 57344
 v_mfma_f32_16x16x32_bf16 v[164:167], a[244:247], v[60:63], v[164:167]
 ds_read_b64_tr_b16 a[238:239], v14 offset:42496
 s_waitcnt lgkmcnt(8)
 v_mfma_f32_16x16x32_bf16 v[156:159], a[248:251], v[48:51], v[156:159]
 ds_read_b64_tr_b16 a[240:241], v15 offset:32768
 buffer_load_dwordx4 v254, s[40:43], s100 offen lds
 v_mfma_f32_16x16x32_bf16 v[156:159], a[252:255], v[56:59], v[156:159]
 ds_read_b64_tr_b16 a[242:243], v15 offset:33280
 s_waitcnt vmcnt(13)
 v_mfma_f32_16x16x32_bf16 v[172:175], a[248:251], v[52:55], v[172:175]
 ds_read_b64_tr_b16 a[244:245], v15 offset:40960
 v_mfma_f32_16x16x32_bf16 v[172:175], a[252:255], v[60:63], v[172:175]
 ds_read_b64_tr_b16 a[246:247], v15 offset:41472
 s_waitcnt lgkmcnt(8)
 v_mfma_f32_16x16x32_bf16 v[176:179], a[224:227], v[48:51], v[176:179]
 ds_read_b64_tr_b16 a[248:249], v15 offset:33792
 ds_read_b64_tr_b16 a[98:99], v8 offset:2048
 v_mfma_f32_16x16x32_bf16 v[176:179], a[228:231], v[56:59], v[176:179]
 ds_read_b64_tr_b16 a[250:251], v15 offset:34304
 ds_read_b64_tr_b16 a[102:103], v255 offset:2048
 v_mfma_f32_16x16x32_bf16 v[192:195], a[224:227], v[52:55], v[192:195]
 ds_read_b64_tr_b16 a[252:253], v15 offset:41984
 v_mfma_f32_16x16x32_bf16 v[192:195], a[228:231], v[60:63], v[192:195]
 ds_read_b64_tr_b16 a[254:255], v15 offset:42496
 s_waitcnt lgkmcnt(10)
 v_mfma_f32_16x16x32_bf16 v[184:187], a[232:235], v[48:51], v[184:187]
 ds_read_b64_tr_b16 a[224:225], v12 offset:49152
 ds_read_b64_tr_b16 a[106:107], v253 offset:2048
 v_mfma_f32_16x16x32_bf16 v[184:187], a[236:239], v[56:59], v[184:187]
 ds_read_b64_tr_b16 a[226:227], v12 offset:49664
 ds_read_b64_tr_b16 a[110:111], v251 offset:2048
 v_mfma_f32_16x16x32_bf16 v[200:203], a[232:235], v[52:55], v[200:203]
 ds_read_b64_tr_b16 a[228:229], v12 offset:57344
 v_mfma_f32_16x16x32_bf16 v[200:203], a[236:239], v[60:63], v[200:203]
 ds_read_b64_tr_b16 a[230:231], v12 offset:57856
 s_waitcnt lgkmcnt(12)
 v_mfma_f32_16x16x32_bf16 v[180:183], a[240:243], v[48:51], v[180:183]
 ds_read_b64_tr_b16 a[232:233], v12 offset:50176
 s_add_u32 m0, s55, 0
 v_mfma_f32_16x16x32_bf16 v[180:183], a[244:247], v[56:59], v[180:183]
 ds_read_b64_tr_b16 a[234:235], v12 offset:50688
 v_mfma_f32_16x16x32_bf16 v[196:199], a[240:243], v[52:55], v[196:199]
 ds_read_b64_tr_b16 a[236:237], v12 offset:58368
 v_mfma_f32_16x16x32_bf16 v[196:199], a[244:247], v[60:63], v[196:199]
 ds_read_b64_tr_b16 a[238:239], v12 offset:58880
 s_waitcnt lgkmcnt(10)
 v_mfma_f32_16x16x32_bf16 v[188:191], a[248:251], v[48:51], v[188:191]
 ds_read_b64_tr_b16 a[240:241], v13 offset:49152
 buffer_load_dwordx4 v254, s[40:43], s84 offen lds
 v_mfma_f32_16x16x32_bf16 v[188:191], a[252:255], v[56:59], v[188:191]
 ds_read_b64_tr_b16 a[242:243], v13 offset:49664
 s_add_u32 m0, s55, 1024
 v_mfma_f32_16x16x32_bf16 v[204:207], a[248:251], v[52:55], v[204:207]
 ds_read_b64_tr_b16 a[244:245], v13 offset:57344
 s_add_u32 s100, s84, 8192
 v_mfma_f32_16x16x32_bf16 v[204:207], a[252:255], v[60:63], v[204:207]
 ds_read_b64_tr_b16 a[246:247], v13 offset:57856
 s_waitcnt lgkmcnt(8)
 v_mfma_f32_16x16x32_bf16 v[144:147], a[224:227], v[64:67], v[144:147]
 ds_read_b64_tr_b16 a[248:249], v13 offset:50176
 buffer_load_dwordx4 v[48:51], v223, s[48:51], s14 offen offset:0 sc1
 v_mfma_f32_16x16x32_bf16 v[144:147], a[228:231], v[72:75], v[144:147]
 ds_read_b64_tr_b16 a[250:251], v13 offset:50688
 v_mfma_f32_16x16x32_bf16 v[160:163], a[224:227], v[68:71], v[160:163]
 ds_read_b64_tr_b16 a[252:253], v13 offset:58368
 buffer_load_dwordx4 v[52:55], v223, s[48:51], s14 offen offset:256 sc1
 v_mfma_f32_16x16x32_bf16 v[160:163], a[228:231], v[76:79], v[160:163]
 ds_read_b64_tr_b16 a[254:255], v13 offset:58880
 s_waitcnt lgkmcnt(8)
 v_mfma_f32_16x16x32_bf16 v[152:155], a[232:235], v[64:67], v[152:155]
 ds_read_b64_tr_b16 a[224:225], v14 offset:49152
 buffer_load_dwordx4 v[56:59], v223, s[48:51], s14 offen offset:2048 sc1
 v_mfma_f32_16x16x32_bf16 v[152:155], a[236:239], v[72:75], v[152:155]
 ds_read_b64_tr_b16 a[226:227], v14 offset:49664
 v_mfma_f32_16x16x32_bf16 v[168:171], a[232:235], v[68:71], v[168:171]
 ds_read_b64_tr_b16 a[228:229], v14 offset:57344
 buffer_load_dwordx4 v[60:63], v223, s[48:51], s14 offen offset:2304 sc1
 v_mfma_f32_16x16x32_bf16 v[168:171], a[236:239], v[76:79], v[168:171]
 ds_read_b64_tr_b16 a[230:231], v14 offset:57856
 s_waitcnt lgkmcnt(8)
 v_mfma_f32_16x16x32_bf16 v[148:151], a[240:243], v[64:67], v[148:151]
 ds_read_b64_tr_b16 a[232:233], v14 offset:50176
 buffer_load_dwordx4 v254, s[40:43], s100 offen lds
 v_mfma_f32_16x16x32_bf16 v[148:151], a[244:247], v[72:75], v[148:151]
 ds_read_b64_tr_b16 a[234:235], v14 offset:50688
 s_waitcnt vmcnt(12)
 v_mfma_f32_16x16x32_bf16 v[164:167], a[240:243], v[68:71], v[164:167]
 ds_read_b64_tr_b16 a[236:237], v14 offset:58368
 ds_read_b64_tr_b16 a[112:113], v8 offset:4096
 v_mfma_f32_16x16x32_bf16 v[164:167], a[244:247], v[76:79], v[164:167]
 ds_read_b64_tr_b16 a[238:239], v14 offset:58880
 s_waitcnt lgkmcnt(9)
 v_mfma_f32_16x16x32_bf16 v[156:159], a[248:251], v[64:67], v[156:159]
 ds_read_b64_tr_b16 a[240:241], v15 offset:49152
 ds_read_b64_tr_b16 a[116:117], v255 offset:4096
 v_mfma_f32_16x16x32_bf16 v[156:159], a[252:255], v[72:75], v[156:159]
 ds_read_b64_tr_b16 a[242:243], v15 offset:49664
 ds_read_b64_tr_b16 a[120:121], v253 offset:4096
 v_mfma_f32_16x16x32_bf16 v[172:175], a[248:251], v[68:71], v[172:175]
 ds_read_b64_tr_b16 a[244:245], v15 offset:57344
 ds_read_b64_tr_b16 a[124:125], v251 offset:4096
 v_mfma_f32_16x16x32_bf16 v[172:175], a[252:255], v[76:79], v[172:175]
 ds_read_b64_tr_b16 a[246:247], v15 offset:57856
 s_waitcnt lgkmcnt(12)
 v_mfma_f32_16x16x32_bf16 v[176:179], a[224:227], v[64:67], v[176:179]
 ds_read_b64_tr_b16 a[248:249], v15 offset:50176
 s_add_u32 m0, s55, 2048
 v_mfma_f32_16x16x32_bf16 v[176:179], a[228:231], v[72:75], v[176:179]
 ds_read_b64_tr_b16 a[250:251], v15 offset:50688
 s_add_u32 s100, s84, 16384
 v_mfma_f32_16x16x32_bf16 v[192:195], a[224:227], v[68:71], v[192:195]
 ds_read_b64_tr_b16 a[252:253], v15 offset:58368
 buffer_load_dwordx4 v254, s[40:43], s100 offen lds
 v_mfma_f32_16x16x32_bf16 v[192:195], a[228:231], v[76:79], v[192:195]
 ds_read_b64_tr_b16 a[254:255], v15 offset:58880
 s_waitcnt lgkmcnt(11)
 v_mfma_f32_16x16x32_bf16 v[184:187], a[232:235], v[64:67], v[184:187]
 v_xor_b32 v12, 0x10000, v12
 ds_read_b64_tr_b16 a[224:225], v12 offset:0
 v_mfma_f32_16x16x32_bf16 v[184:187], a[236:239], v[72:75], v[184:187]
 ds_read_b64_tr_b16 a[226:227], v12 offset:512
 s_add_u32 m0, s55, 3072
 v_mfma_f32_16x16x32_bf16 v[200:203], a[232:235], v[68:71], v[200:203]
 ds_read_b64_tr_b16 a[228:229], v12 offset:8192
 v_mfma_f32_16x16x32_bf16 v[200:203], a[236:239], v[76:79], v[200:203]
 ds_read_b64_tr_b16 a[230:231], v12 offset:8704
 s_waitcnt lgkmcnt(8)
 v_mfma_f32_16x16x32_bf16 v[180:183], a[240:243], v[64:67], v[180:183]
 ds_read_b64_tr_b16 a[232:233], v12 offset:1024
 s_add_u32 s100, s84, 24576
 v_mfma_f32_16x16x32_bf16 v[180:183], a[244:247], v[72:75], v[180:183]
 ds_read_b64_tr_b16 a[234:235], v12 offset:1536
 buffer_load_dwordx4 v254, s[40:43], s100 offen lds
 v_mfma_f32_16x16x32_bf16 v[196:199], a[240:243], v[68:71], v[196:199]
 ds_read_b64_tr_b16 a[236:237], v12 offset:9216
 v_mfma_f32_16x16x32_bf16 v[196:199], a[244:247], v[76:79], v[196:199]
 ds_read_b64_tr_b16 a[238:239], v12 offset:9728
 s_waitcnt lgkmcnt(8)
 v_mfma_f32_16x16x32_bf16 v[188:191], a[248:251], v[64:67], v[188:191]
 v_xor_b32 v13, 0x10000, v13
 ds_read_b64_tr_b16 a[240:241], v13 offset:0
 v_mfma_f32_16x16x32_bf16 v[188:191], a[252:255], v[72:75], v[188:191]
 ds_read_b64_tr_b16 a[242:243], v13 offset:512
 s_waitcnt vmcnt(8)
 v_mfma_f32_16x16x32_bf16 v[204:207], a[248:251], v[68:71], v[204:207]
 ds_read_b64_tr_b16 a[244:245], v13 offset:8192
 ds_read_b64_tr_b16 a[114:115], v8 offset:6144
 v_mfma_f32_16x16x32_bf16 v[204:207], a[252:255], v[76:79], v[204:207]
 ds_read_b64_tr_b16 a[246:247], v13 offset:8704
 s_waitcnt lgkmcnt(9)
 v_mfma_f32_16x16x32_bf16 v[144:147], a[224:227], v[16:19], v[144:147]
 ds_read_b64_tr_b16 a[248:249], v13 offset:1024
 buffer_load_dwordx4 v[64:67], v223, s[48:51], s15 offen offset:0 sc1
 v_mfma_f32_16x16x32_bf16 v[144:147], a[228:231], v[24:27], v[144:147]
 ds_read_b64_tr_b16 a[250:251], v13 offset:1536
 ds_read_b64_tr_b16 a[118:119], v255 offset:6144
 v_mfma_f32_16x16x32_bf16 v[160:163], a[224:227], v[20:23], v[160:163]
 ds_read_b64_tr_b16 a[252:253], v13 offset:9216
 buffer_load_dwordx4 v[68:71], v223, s[48:51], s15 offen offset:256 sc1
 v_mfma_f32_16x16x32_bf16 v[160:163], a[228:231], v[28:31], v[160:163]
 ds_read_b64_tr_b16 a[254:255], v13 offset:9728
 s_waitcnt lgkmcnt(10)
 v_mfma_f32_16x16x32_bf16 v[152:155], a[232:235], v[16:19], v[152:155]
 v_xor_b32 v14, 0x10000, v14
 ds_read_b64_tr_b16 a[224:225], v14 offset:0
 v_mfma_f32_16x16x32_bf16 v[152:155], a[236:239], v[24:27], v[152:155]
 ds_read_b64_tr_b16 a[226:227], v14 offset:512
 buffer_load_dwordx4 v[72:75], v223, s[48:51], s15 offen offset:2048 sc1
 v_mfma_f32_16x16x32_bf16 v[168:171], a[232:235], v[20:23], v[168:171]
 ds_read_b64_tr_b16 a[228:229], v14 offset:8192
 ds_read_b64_tr_b16 a[122:123], v253 offset:6144
 v_mfma_f32_16x16x32_bf16 v[168:171], a[236:239], v[28:31], v[168:171]
 ds_read_b64_tr_b16 a[230:231], v14 offset:8704
 s_waitcnt lgkmcnt(10)
 v_mfma_f32_16x16x32_bf16 v[148:151], a[240:243], v[16:19], v[148:151]
 ds_read_b64_tr_b16 a[232:233], v14 offset:1024
 buffer_load_dwordx4 v[76:79], v223, s[48:51], s15 offen offset:2304 sc1
 v_mfma_f32_16x16x32_bf16 v[148:151], a[244:247], v[24:27], v[148:151]
 ds_read_b64_tr_b16 a[234:235], v14 offset:1536
 ds_read_b64_tr_b16 a[126:127], v251 offset:6144
 v_mfma_f32_16x16x32_bf16 v[164:167], a[240:243], v[20:23], v[164:167]
 ds_read_b64_tr_b16 a[236:237], v14 offset:9216
 buffer_load_dwordx4 v[224:227], v6, s[48:51], s16 offen offset:0 sc1
 v_mfma_f32_16x16x32_bf16 v[164:167], a[244:247], v[28:31], v[164:167]
 ds_read_b64_tr_b16 a[238:239], v14 offset:9728
 s_waitcnt lgkmcnt(10)
 v_mfma_f32_16x16x32_bf16 v[156:159], a[248:251], v[16:19], v[156:159]
 v_xor_b32 v15, 0x10000, v15
 ds_read_b64_tr_b16 a[240:241], v15 offset:0
 v_mfma_f32_16x16x32_bf16 v[156:159], a[252:255], v[24:27], v[156:159]
 ds_read_b64_tr_b16 a[242:243], v15 offset:512
 buffer_load_dwordx4 v[228:231], v6, s[48:51], s16 offen offset:1024 sc1
 v_mfma_f32_16x16x32_bf16 v[172:175], a[248:251], v[20:23], v[172:175]
 ds_read_b64_tr_b16 a[244:245], v15 offset:8192
 s_add_u32 m0, s55, 4096
 v_mfma_f32_16x16x32_bf16 v[172:175], a[252:255], v[28:31], v[172:175]
 ds_read_b64_tr_b16 a[246:247], v15 offset:8704
 s_waitcnt lgkmcnt(9)
 v_mfma_f32_16x16x32_bf16 v[176:179], a[224:227], v[16:19], v[176:179]
 ds_read_b64_tr_b16 a[248:249], v15 offset:1024
 buffer_load_dwordx4 v[232:235], v6, s[48:51], s16 offen offset:2048 sc1
 v_mfma_f32_16x16x32_bf16 v[176:179], a[228:231], v[24:27], v[176:179]
 ds_read_b64_tr_b16 a[250:251], v15 offset:1536
 s_add_u32 s100, s84, 32768
 v_mfma_f32_16x16x32_bf16 v[192:195], a[224:227], v[20:23], v[192:195]
 ds_read_b64_tr_b16 a[252:253], v15 offset:9216
 buffer_load_dwordx4 v[236:239], v6, s[48:51], s16 offen offset:3072 sc1
 v_mfma_f32_16x16x32_bf16 v[192:195], a[228:231], v[28:31], v[192:195]
 ds_read_b64_tr_b16 a[254:255], v15 offset:9728
 s_waitcnt lgkmcnt(8)
 v_mfma_f32_16x16x32_bf16 v[184:187], a[232:235], v[16:19], v[184:187]
 ds_read_b64_tr_b16 a[224:225], v12 offset:16384
 buffer_load_dword v212, v2, s[48:51], s16 offen sc1
 v_mfma_f32_16x16x32_bf16 v[184:187], a[236:239], v[24:27], v[184:187]
 ds_read_b64_tr_b16 a[226:227], v12 offset:16896
 v_mfma_f32_16x16x32_bf16 v[200:203], a[232:235], v[20:23], v[200:203]
 ds_read_b64_tr_b16 a[228:229], v12 offset:24576
 buffer_load_dwordx4 v254, s[40:43], s100 offen lds
 v_mfma_f32_16x16x32_bf16 v[200:203], a[236:239], v[28:31], v[200:203]
 ds_read_b64_tr_b16 a[230:231], v12 offset:25088
 s_waitcnt lgkmcnt(8)
 v_mfma_f32_16x16x32_bf16 v[180:183], a[240:243], v[16:19], v[180:183]
 ds_read_b64_tr_b16 a[232:233], v12 offset:17408
 s_add_u32 m0, s55, 5120
 v_mfma_f32_16x16x32_bf16 v[180:183], a[244:247], v[24:27], v[180:183]
 ds_read_b64_tr_b16 a[234:235], v12 offset:17920
 s_add_u32 s100, s84, 40960
 v_mfma_f32_16x16x32_bf16 v[196:199], a[240:243], v[20:23], v[196:199]
 ds_read_b64_tr_b16 a[236:237], v12 offset:25600
 buffer_load_dwordx4 v254, s[40:43], s100 offen lds
 v_mfma_f32_16x16x32_bf16 v[196:199], a[244:247], v[28:31], v[196:199]
 ds_read_b64_tr_b16 a[238:239], v12 offset:26112
 s_waitcnt lgkmcnt(8)
 v_mfma_f32_16x16x32_bf16 v[188:191], a[248:251], v[16:19], v[188:191]
 ds_read_b64_tr_b16 a[240:241], v13 offset:16384
 s_waitcnt vmcnt(13)
 v_mfma_f32_16x16x32_bf16 v[188:191], a[252:255], v[24:27], v[188:191]
 ds_read_b64_tr_b16 a[242:243], v13 offset:16896
 ds_read_b64_tr_b16 a[128:129], v8 offset:0
 v_mfma_f32_16x16x32_bf16 v[204:207], a[248:251], v[20:23], v[204:207]
 ds_read_b64_tr_b16 a[244:245], v13 offset:24576
 ds_read_b64_tr_b16 a[132:133], v255 offset:0
 v_mfma_f32_16x16x32_bf16 v[204:207], a[252:255], v[28:31], v[204:207]
 ds_read_b64_tr_b16 a[246:247], v13 offset:25088
 s_waitcnt lgkmcnt(10)
 v_mfma_f32_16x16x32_bf16 v[144:147], a[224:227], v[32:35], v[144:147]
 ds_read_b64_tr_b16 a[248:249], v13 offset:17408
 buffer_load_dwordx4 v[80:83], v6, s[48:51], s17 offen offset:0 sc1
 v_mfma_f32_16x16x32_bf16 v[144:147], a[228:231], v[40:43], v[144:147]
 ds_read_b64_tr_b16 a[250:251], v13 offset:17920
 ds_read_b64_tr_b16 a[136:137], v253 offset:0
 v_mfma_f32_16x16x32_bf16 v[160:163], a[224:227], v[36:39], v[160:163]
 ds_read_b64_tr_b16 a[252:253], v13 offset:25600
 buffer_load_dwordx4 v[84:87], v6, s[48:51], s17 offen offset:1024 sc1
 v_mfma_f32_16x16x32_bf16 v[160:163], a[228:231], v[44:47], v[160:163]
 ds_read_b64_tr_b16 a[254:255], v13 offset:26112
 s_waitcnt lgkmcnt(11)
 v_mfma_f32_16x16x32_bf16 v[152:155], a[232:235], v[32:35], v[152:155]
 ds_read_b64_tr_b16 a[224:225], v14 offset:16384
 buffer_load_dwordx4 v[88:91], v6, s[48:51], s17 offen offset:2048 sc1
 v_mfma_f32_16x16x32_bf16 v[152:155], a[236:239], v[40:43], v[152:155]
 ds_read_b64_tr_b16 a[226:227], v14 offset:16896
 ds_read_b64_tr_b16 a[140:141], v251 offset:0
 v_mfma_f32_16x16x32_bf16 v[168:171], a[232:235], v[36:39], v[168:171]
 ds_read_b64_tr_b16 a[228:229], v14 offset:24576
 buffer_load_dwordx4 v[92:95], v6, s[48:51], s17 offen offset:3072 sc1
 v_mfma_f32_16x16x32_bf16 v[168:171], a[236:239], v[44:47], v[168:171]
 ds_read_b64_tr_b16 a[230:231], v14 offset:25088
 s_waitcnt lgkmcnt(10)
 v_mfma_f32_16x16x32_bf16 v[148:151], a[240:243], v[32:35], v[148:151]
 ds_read_b64_tr_b16 a[232:233], v14 offset:17408
 buffer_load_dword v213, v2, s[48:51], s17 offen sc1
 v_mfma_f32_16x16x32_bf16 v[148:151], a[244:247], v[40:43], v[148:151]
 ds_read_b64_tr_b16 a[234:235], v14 offset:17920
 s_add_u32 m0, s55, 6144
 v_mfma_f32_16x16x32_bf16 v[164:167], a[240:243], v[36:39], v[164:167]
 ds_read_b64_tr_b16 a[236:237], v14 offset:25600
 s_add_u32 s100, s84, 49152
 v_mfma_f32_16x16x32_bf16 v[164:167], a[244:247], v[44:47], v[164:167]
 ds_read_b64_tr_b16 a[238:239], v14 offset:26112
 s_waitcnt lgkmcnt(9)
 v_mfma_f32_16x16x32_bf16 v[156:159], a[248:251], v[32:35], v[156:159]
 ds_read_b64_tr_b16 a[240:241], v15 offset:16384
 buffer_load_dwordx4 v254, s[40:43], s100 offen lds
 v_mfma_f32_16x16x32_bf16 v[156:159], a[252:255], v[40:43], v[156:159]
 ds_read_b64_tr_b16 a[242:243], v15 offset:16896
 s_add_u32 m0, s55, 7168
 v_mfma_f32_16x16x32_bf16 v[172:175], a[248:251], v[36:39], v[172:175]
 ds_read_b64_tr_b16 a[244:245], v15 offset:24576
 s_add_u32 s100, s84, 57344
 v_mfma_f32_16x16x32_bf16 v[172:175], a[252:255], v[44:47], v[172:175]
 ds_read_b64_tr_b16 a[246:247], v15 offset:25088
 s_waitcnt lgkmcnt(8)
 v_mfma_f32_16x16x32_bf16 v[176:179], a[224:227], v[32:35], v[176:179]
 ds_read_b64_tr_b16 a[248:249], v15 offset:17408
 buffer_load_dwordx4 v254, s[40:43], s100 offen lds
 v_mfma_f32_16x16x32_bf16 v[176:179], a[228:231], v[40:43], v[176:179]
 ds_read_b64_tr_b16 a[250:251], v15 offset:17920
 s_waitcnt vmcnt(18)
 v_mfma_f32_16x16x32_bf16 v[192:195], a[224:227], v[36:39], v[192:195]
 ds_read_b64_tr_b16 a[252:253], v15 offset:25600
 ds_read_b64_tr_b16 a[130:131], v8 offset:2048
 v_mfma_f32_16x16x32_bf16 v[192:195], a[228:231], v[44:47], v[192:195]
 ds_read_b64_tr_b16 a[254:255], v15 offset:26112
 s_waitcnt lgkmcnt(9)
 v_mfma_f32_16x16x32_bf16 v[184:187], a[232:235], v[32:35], v[184:187]
 ds_read_b64_tr_b16 a[224:225], v12 offset:32768
 ds_read_b64_tr_b16 a[134:135], v255 offset:2048
 v_mfma_f32_16x16x32_bf16 v[184:187], a[236:239], v[40:43], v[184:187]
 ds_read_b64_tr_b16 a[226:227], v12 offset:33280
 ds_read_b64_tr_b16 a[138:139], v253 offset:2048
 v_mfma_f32_16x16x32_bf16 v[200:203], a[232:235], v[36:39], v[200:203]
 ds_read_b64_tr_b16 a[228:229], v12 offset:40960
 ds_read_b64_tr_b16 a[142:143], v251 offset:2048
 v_mfma_f32_16x16x32_bf16 v[200:203], a[236:239], v[44:47], v[200:203]
 ds_read_b64_tr_b16 a[230:231], v12 offset:41472
 s_waitcnt lgkmcnt(12)
 v_mfma_f32_16x16x32_bf16 v[180:183], a[240:243], v[32:35], v[180:183]
 ds_read_b64_tr_b16 a[232:233], v12 offset:33792
 buffer_load_dwordx4 v[96:99], v6, s[48:51], s18 offen offset:0 sc1
 v_mfma_f32_16x16x32_bf16 v[180:183], a[244:247], v[40:43], v[180:183]
 ds_read_b64_tr_b16 a[234:235], v12 offset:34304
 s_waitcnt vmcnt(8)
 v_mfma_f32_16x16x32_bf16 v[196:199], a[240:243], v[36:39], v[196:199]
 ds_read_b64_tr_b16 a[236:237], v12 offset:41984
 buffer_load_dwordx4 v[100:103], v6, s[48:51], s18 offen offset:1024 sc1
 v_mfma_f32_16x16x32_bf16 v[196:199], a[244:247], v[44:47], v[196:199]
 ds_read_b64_tr_b16 a[238:239], v12 offset:42496
 s_waitcnt lgkmcnt(11)
 v_mfma_f32_16x16x32_bf16 v[188:191], a[248:251], v[32:35], v[188:191]
 ds_read_b64_tr_b16 a[240:241], v13 offset:32768
 buffer_load_dwordx4 v[104:107], v6, s[48:51], s18 offen offset:2048 sc1
 v_mfma_f32_16x16x32_bf16 v[188:191], a[252:255], v[40:43], v[188:191]
 ds_read_b64_tr_b16 a[242:243], v13 offset:33280
 ds_read_b64_tr_b16 a[144:145], v8 offset:4096
 v_mfma_f32_16x16x32_bf16 v[204:207], a[248:251], v[36:39], v[204:207]
 ds_read_b64_tr_b16 a[244:245], v13 offset:40960
 buffer_load_dwordx4 v[108:111], v6, s[48:51], s18 offen offset:3072 sc1
 v_mfma_f32_16x16x32_bf16 v[204:207], a[252:255], v[44:47], v[204:207]
 ds_read_b64_tr_b16 a[246:247], v13 offset:41472
 buffer_load_dword v214, v2, s[48:51], s18 offen sc1
 s_waitcnt lgkmcnt(9)
 v_mfma_f32_16x16x32_bf16 v[144:147], a[224:227], v[48:51], v[144:147]
 ds_read_b64_tr_b16 a[248:249], v13 offset:33792
 ds_read_b64_tr_b16 a[148:149], v255 offset:4096
 v_mfma_f32_16x16x32_bf16 v[144:147], a[228:231], v[56:59], v[144:147]
 ds_read_b64_tr_b16 a[250:251], v13 offset:34304
 ds_read_b64_tr_b16 a[152:153], v253 offset:4096
 v_mfma_f32_16x16x32_bf16 v[160:163], a[224:227], v[52:55], v[160:163]
 ds_read_b64_tr_b16 a[252:253], v13 offset:41984
 ds_read_b64_tr_b16 a[156:157], v251 offset:4096
 v_mfma_f32_16x16x32_bf16 v[160:163], a[228:231], v[60:63], v[160:163]
 ds_read_b64_tr_b16 a[254:255], v13 offset:42496
 s_waitcnt lgkmcnt(12)
 v_mfma_f32_16x16x32_bf16 v[152:155], a[232:235], v[48:51], v[152:155]
 ds_read_b64_tr_b16 a[224:225], v14 offset:32768
 s_waitcnt vmcnt(5)
 v_mfma_f32_16x16x32_bf16 v[152:155], a[236:239], v[56:59], v[152:155]
 ds_read_b64_tr_b16 a[226:227], v14 offset:33280
 ds_read_b64_tr_b16 a[146:147], v8 offset:6144
 v_mfma_f32_16x16x32_bf16 v[168:171], a[232:235], v[52:55], v[168:171]
 ds_read_b64_tr_b16 a[228:229], v14 offset:40960
 v_mfma_f32_16x16x32_bf16 v[168:171], a[236:239], v[60:63], v[168:171]
 ds_read_b64_tr_b16 a[230:231], v14 offset:41472
 s_waitcnt lgkmcnt(12)
 v_mfma_f32_16x16x32_bf16 v[148:151], a[240:243], v[48:51], v[148:151]
 ds_read_b64_tr_b16 a[232:233], v14 offset:33792
 ds_read_b64_tr_b16 a[150:151], v255 offset:6144
 v_mfma_f32_16x16x32_bf16 v[148:151], a[244:247], v[56:59], v[148:151]
 ds_read_b64_tr_b16 a[234:235], v14 offset:34304
 ds_read_b64_tr_b16 a[154:155], v253 offset:6144
 v_mfma_f32_16x16x32_bf16 v[164:167], a[240:243], v[52:55], v[164:167]
 ds_read_b64_tr_b16 a[236:237], v14 offset:41984
 v_mfma_f32_16x16x32_bf16 v[164:167], a[244:247], v[60:63], v[164:167]
 ds_read_b64_tr_b16 a[238:239], v14 offset:42496
 s_waitcnt lgkmcnt(11)
 v_mfma_f32_16x16x32_bf16 v[156:159], a[248:251], v[48:51], v[156:159]
 ds_read_b64_tr_b16 a[240:241], v15 offset:32768
 ds_read_b64_tr_b16 a[158:159], v251 offset:6144
 v_mfma_f32_16x16x32_bf16 v[156:159], a[252:255], v[56:59], v[156:159]
 ds_read_b64_tr_b16 a[242:243], v15 offset:33280
 v_mfma_f32_16x16x32_bf16 v[172:175], a[248:251], v[52:55], v[172:175]
 ds_read_b64_tr_b16 a[244:245], v15 offset:40960
 v_mfma_f32_16x16x32_bf16 v[172:175], a[252:255], v[60:63], v[172:175]
 ds_read_b64_tr_b16 a[246:247], v15 offset:41472
 s_waitcnt lgkmcnt(11)
 v_mfma_f32_16x16x32_bf16 v[176:179], a[224:227], v[48:51], v[176:179]
 ds_read_b64_tr_b16 a[248:249], v15 offset:33792
 buffer_load_dwordx4 v[112:115], v6, s[48:51], s19 offen offset:0 sc1
 v_mfma_f32_16x16x32_bf16 v[176:179], a[228:231], v[56:59], v[176:179]
 ds_read_b64_tr_b16 a[250:251], v15 offset:34304
 v_mfma_f32_16x16x32_bf16 v[192:195], a[224:227], v[52:55], v[192:195]
 ds_read_b64_tr_b16 a[252:253], v15 offset:41984
 buffer_load_dwordx4 v[116:119], v6, s[48:51], s19 offen offset:1024 sc1
 v_mfma_f32_16x16x32_bf16 v[192:195], a[228:231], v[60:63], v[192:195]
 ds_read_b64_tr_b16 a[254:255], v15 offset:42496
 s_waitcnt lgkmcnt(9)
 v_mfma_f32_16x16x32_bf16 v[184:187], a[232:235], v[48:51], v[184:187]
 ds_read_b64_tr_b16 a[224:225], v12 offset:49152
 buffer_load_dwordx4 v[120:123], v6, s[48:51], s19 offen offset:2048 sc1
 v_mfma_f32_16x16x32_bf16 v[184:187], a[236:239], v[56:59], v[184:187]
 ds_read_b64_tr_b16 a[226:227], v12 offset:49664
 v_mfma_f32_16x16x32_bf16 v[200:203], a[232:235], v[52:55], v[200:203]
 ds_read_b64_tr_b16 a[228:229], v12 offset:57344
 buffer_load_dwordx4 v[124:127], v6, s[48:51], s19 offen offset:3072 sc1
 v_mfma_f32_16x16x32_bf16 v[200:203], a[236:239], v[60:63], v[200:203]
 ds_read_b64_tr_b16 a[230:231], v12 offset:57856
 s_waitcnt lgkmcnt(8)
 v_mfma_f32_16x16x32_bf16 v[180:183], a[240:243], v[48:51], v[180:183]
 ds_read_b64_tr_b16 a[232:233], v12 offset:50176
 buffer_load_dword v215, v2, s[48:51], s19 offen sc1
 v_mfma_f32_16x16x32_bf16 v[180:183], a[244:247], v[56:59], v[180:183]
 ds_read_b64_tr_b16 a[234:235], v12 offset:50688
 v_mfma_f32_16x16x32_bf16 v[196:199], a[240:243], v[52:55], v[196:199]
 ds_read_b64_tr_b16 a[236:237], v12 offset:58368
 v_mfma_f32_16x16x32_bf16 v[196:199], a[244:247], v[60:63], v[196:199]
 ds_read_b64_tr_b16 a[238:239], v12 offset:58880
 s_waitcnt lgkmcnt(8)
 v_mfma_f32_16x16x32_bf16 v[188:191], a[248:251], v[48:51], v[188:191]
 ds_read_b64_tr_b16 a[240:241], v13 offset:49152
 v_mfma_f32_16x16x32_bf16 v[188:191], a[252:255], v[56:59], v[188:191]
 ds_read_b64_tr_b16 a[242:243], v13 offset:49664
 v_mfma_f32_16x16x32_bf16 v[204:207], a[248:251], v[52:55], v[204:207]
 ds_read_b64_tr_b16 a[244:245], v13 offset:57344
 v_mfma_f32_16x16x32_bf16 v[204:207], a[252:255], v[60:63], v[204:207]
 ds_read_b64_tr_b16 a[246:247], v13 offset:57856
 s_waitcnt lgkmcnt(8)
 v_mfma_f32_16x16x32_bf16 v[144:147], a[224:227], v[64:67], v[144:147]
 ds_read_b64_tr_b16 a[248:249], v13 offset:50176
 v_mfma_f32_16x16x32_bf16 v[144:147], a[228:231], v[72:75], v[144:147]
 ds_read_b64_tr_b16 a[250:251], v13 offset:50688
 v_mfma_f32_16x16x32_bf16 v[160:163], a[224:227], v[68:71], v[160:163]
 ds_read_b64_tr_b16 a[252:253], v13 offset:58368
 v_mfma_f32_16x16x32_bf16 v[160:163], a[228:231], v[76:79], v[160:163]
 ds_read_b64_tr_b16 a[254:255], v13 offset:58880
 s_waitcnt lgkmcnt(8)
 v_mfma_f32_16x16x32_bf16 v[152:155], a[232:235], v[64:67], v[152:155]
 ds_read_b64_tr_b16 a[224:225], v14 offset:49152
 v_mfma_f32_16x16x32_bf16 v[152:155], a[236:239], v[72:75], v[152:155]
 ds_read_b64_tr_b16 a[226:227], v14 offset:49664
 v_mfma_f32_16x16x32_bf16 v[168:171], a[232:235], v[68:71], v[168:171]
 ds_read_b64_tr_b16 a[228:229], v14 offset:57344
 v_mfma_f32_16x16x32_bf16 v[168:171], a[236:239], v[76:79], v[168:171]
 ds_read_b64_tr_b16 a[230:231], v14 offset:57856
 s_waitcnt lgkmcnt(8)
 v_mfma_f32_16x16x32_bf16 v[148:151], a[240:243], v[64:67], v[148:151]
 ds_read_b64_tr_b16 a[232:233], v14 offset:50176
 buffer_load_dwordx4 v[128:131], v6, s[48:51], s20 offen offset:0 sc1
 v_mfma_f32_16x16x32_bf16 v[148:151], a[244:247], v[72:75], v[148:151]
 ds_read_b64_tr_b16 a[234:235], v14 offset:50688
 v_mfma_f32_16x16x32_bf16 v[164:167], a[240:243], v[68:71], v[164:167]
 ds_read_b64_tr_b16 a[236:237], v14 offset:58368
 buffer_load_dwordx4 v[132:135], v6, s[48:51], s20 offen offset:1024 sc1
 v_mfma_f32_16x16x32_bf16 v[164:167], a[244:247], v[76:79], v[164:167]
 ds_read_b64_tr_b16 a[238:239], v14 offset:58880
 s_waitcnt lgkmcnt(8)
 v_mfma_f32_16x16x32_bf16 v[156:159], a[248:251], v[64:67], v[156:159]
 ds_read_b64_tr_b16 a[240:241], v15 offset:49152
 buffer_load_dwordx4 v[136:139], v6, s[48:51], s20 offen offset:2048 sc1
 v_mfma_f32_16x16x32_bf16 v[156:159], a[252:255], v[72:75], v[156:159]
 ds_read_b64_tr_b16 a[242:243], v15 offset:49664
 v_mfma_f32_16x16x32_bf16 v[172:175], a[248:251], v[68:71], v[172:175]
 ds_read_b64_tr_b16 a[244:245], v15 offset:57344
 buffer_load_dwordx4 v[140:143], v6, s[48:51], s20 offen offset:3072 sc1
 v_mfma_f32_16x16x32_bf16 v[172:175], a[252:255], v[76:79], v[172:175]
 ds_read_b64_tr_b16 a[246:247], v15 offset:57856
 s_waitcnt lgkmcnt(8)
 v_mfma_f32_16x16x32_bf16 v[176:179], a[224:227], v[64:67], v[176:179]
 ds_read_b64_tr_b16 a[248:249], v15 offset:50176
 buffer_load_dword v216, v2, s[48:51], s20 offen sc1
 v_mfma_f32_16x16x32_bf16 v[176:179], a[228:231], v[72:75], v[176:179]
 ds_read_b64_tr_b16 a[250:251], v15 offset:50688
 v_mfma_f32_16x16x32_bf16 v[192:195], a[224:227], v[68:71], v[192:195]
 ds_read_b64_tr_b16 a[252:253], v15 offset:58368
 v_mfma_f32_16x16x32_bf16 v[192:195], a[228:231], v[76:79], v[192:195]
 ds_read_b64_tr_b16 a[254:255], v15 offset:58880
 s_waitcnt lgkmcnt(8)
 v_mfma_f32_16x16x32_bf16 v[184:187], a[232:235], v[64:67], v[184:187]
 v_mfma_f32_16x16x32_bf16 v[184:187], a[236:239], v[72:75], v[184:187]
 v_mfma_f32_16x16x32_bf16 v[200:203], a[232:235], v[68:71], v[200:203]
 v_mfma_f32_16x16x32_bf16 v[200:203], a[236:239], v[76:79], v[200:203]
 s_waitcnt lgkmcnt(4)
 v_mfma_f32_16x16x32_bf16 v[180:183], a[240:243], v[64:67], v[180:183]
 v_mfma_f32_16x16x32_bf16 v[180:183], a[244:247], v[72:75], v[180:183]
 v_mfma_f32_16x16x32_bf16 v[196:199], a[240:243], v[68:71], v[196:199]
 v_mfma_f32_16x16x32_bf16 v[196:199], a[244:247], v[76:79], v[196:199]
 s_waitcnt lgkmcnt(0)
 v_mfma_f32_16x16x32_bf16 v[188:191], a[248:251], v[64:67], v[188:191]
 v_mfma_f32_16x16x32_bf16 v[188:191], a[252:255], v[72:75], v[188:191]
 v_mfma_f32_16x16x32_bf16 v[204:207], a[248:251], v[68:71], v[204:207]
 v_mfma_f32_16x16x32_bf16 v[204:207], a[252:255], v[76:79], v[204:207]
 s_mov_b32 s4, 0xbfb8aa3b
 s_mov_b32 s5, 0xbfb8aa3b
 v_pk_mul_f32 v[240:241], v[144:145], s[4:5]
 v_pk_mul_f32 v[242:243], v[146:147], s[4:5]
 v_pk_mul_f32 v[244:245], v[148:149], s[4:5]
 v_pk_mul_f32 v[246:247], v[150:151], s[4:5]
 v_exp_f32 v240, v240
 v_exp_f32 v241, v241
 v_exp_f32 v242, v242
 v_exp_f32 v243, v243
 v_exp_f32 v244, v244
 v_exp_f32 v245, v245
 v_exp_f32 v246, v246
 v_exp_f32 v247, v247
 v_pk_add_f32 v[240:241], v[240:241], 1.0 op_sel_hi:[1,0]
 v_pk_add_f32 v[242:243], v[242:243], 1.0 op_sel_hi:[1,0]
 v_pk_add_f32 v[244:245], v[244:245], 1.0 op_sel_hi:[1,0]
 v_pk_add_f32 v[246:247], v[246:247], 1.0 op_sel_hi:[1,0]
 v_rcp_f32 v240, v240
 v_rcp_f32 v241, v241
 v_rcp_f32 v242, v242
 v_rcp_f32 v243, v243
 v_rcp_f32 v244, v244
 v_rcp_f32 v245, v245
 v_rcp_f32 v246, v246
 v_rcp_f32 v247, v247
 v_pk_mul_f32 v[240:241], v[240:241], v[152:153]
 v_pk_mul_f32 v[242:243], v[242:243], v[154:155]
 v_pk_mul_f32 v[244:245], v[244:245], v[156:157]
 v_pk_mul_f32 v[246:247], v[246:247], v[158:159]
 v_cvt_pk_bf16_f32 v144, v240, v241
 v_cvt_pk_bf16_f32 v145, v242, v243
 v_cvt_pk_bf16_f32 v146, v244, v245
 v_cvt_pk_bf16_f32 v147, v246, v247
 buffer_store_dwordx4 v[144:147], v6, s[48:51], s71 offen offset:0 sc1
 v_xad_u32 v222, v144, v145, s61
 v_add3_u32 v222, v222, v146, v147
 v_pk_mul_f32 v[240:241], v[160:161], s[4:5]
 v_pk_mul_f32 v[242:243], v[162:163], s[4:5]
 v_pk_mul_f32 v[244:245], v[164:165], s[4:5]
 v_pk_mul_f32 v[246:247], v[166:167], s[4:5]
 v_exp_f32 v240, v240
 v_exp_f32 v241, v241
 v_exp_f32 v242, v242
 v_exp_f32 v243, v243
 v_exp_f32 v244, v244
 v_exp_f32 v245, v245
 v_exp_f32 v246, v246
 v_exp_f32 v247, v247
 v_pk_add_f32 v[240:241], v[240:241], 1.0 op_sel_hi:[1,0]
 v_pk_add_f32 v[242:243], v[242:243], 1.0 op_sel_hi:[1,0]
 v_pk_add_f32 v[244:245], v[244:245], 1.0 op_sel_hi:[1,0]
 v_pk_add_f32 v[246:247], v[246:247], 1.0 op_sel_hi:[1,0]
 v_rcp_f32 v240, v240
 v_rcp_f32 v241, v241
 v_rcp_f32 v242, v242
 v_rcp_f32 v243, v243
 v_rcp_f32 v244, v244
 v_rcp_f32 v245, v245
 v_rcp_f32 v246, v246
 v_rcp_f32 v247, v247
 v_pk_mul_f32 v[240:241], v[240:241], v[168:169]
 v_pk_mul_f32 v[242:243], v[242:243], v[170:171]
 v_pk_mul_f32 v[244:245], v[244:245], v[172:173]
 v_pk_mul_f32 v[246:247], v[246:247], v[174:175]
 v_cvt_pk_bf16_f32 v160, v240, v241
 v_cvt_pk_bf16_f32 v161, v242, v243
 v_cvt_pk_bf16_f32 v162, v244, v245
 v_cvt_pk_bf16_f32 v163, v246, v247
 buffer_store_dwordx4 v[160:163], v6, s[48:51], s71 offen offset:1024 sc1
 v_xad_u32 v222, v160, v161, v222
 v_add3_u32 v222, v222, v162, v163
 v_pk_mul_f32 v[240:241], v[176:177], s[4:5]
 v_pk_mul_f32 v[242:243], v[178:179], s[4:5]
 v_pk_mul_f32 v[244:245], v[180:181], s[4:5]
 v_pk_mul_f32 v[246:247], v[182:183], s[4:5]
 v_exp_f32 v240, v240
 v_exp_f32 v241, v241
 v_exp_f32 v242, v242
 v_exp_f32 v243, v243
 v_exp_f32 v244, v244
 v_exp_f32 v245, v245
 v_exp_f32 v246, v246
 v_exp_f32 v247, v247
 v_pk_add_f32 v[240:241], v[240:241], 1.0 op_sel_hi:[1,0]
 v_pk_add_f32 v[242:243], v[242:243], 1.0 op_sel_hi:[1,0]
 v_pk_add_f32 v[244:245], v[244:245], 1.0 op_sel_hi:[1,0]
 v_pk_add_f32 v[246:247], v[246:247], 1.0 op_sel_hi:[1,0]
 v_rcp_f32 v240, v240
 v_rcp_f32 v241, v241
 v_rcp_f32 v242, v242
 v_rcp_f32 v243, v243
 v_rcp_f32 v244, v244
 v_rcp_f32 v245, v245
 v_rcp_f32 v246, v246
 v_rcp_f32 v247, v247
 v_pk_mul_f32 v[240:241], v[240:241], v[184:185]
 v_pk_mul_f32 v[242:243], v[242:243], v[186:187]
 v_pk_mul_f32 v[244:245], v[244:245], v[188:189]
 v_pk_mul_f32 v[246:247], v[246:247], v[190:191]
 v_cvt_pk_bf16_f32 v176, v240, v241
 v_cvt_pk_bf16_f32 v177, v242, v243
 v_cvt_pk_bf16_f32 v178, v244, v245
 v_cvt_pk_bf16_f32 v179, v246, v247
 buffer_store_dwordx4 v[176:179], v6, s[48:51], s71 offen offset:2048 sc1
 v_xad_u32 v222, v176, v177, v222
 v_add3_u32 v222, v222, v178, v179
 v_pk_mul_f32 v[240:241], v[192:193], s[4:5]
 v_pk_mul_f32 v[242:243], v[194:195], s[4:5]
 v_pk_mul_f32 v[244:245], v[196:197], s[4:5]
 v_pk_mul_f32 v[246:247], v[198:199], s[4:5]
 v_exp_f32 v240, v240
 v_exp_f32 v241, v241
 v_exp_f32 v242, v242
 v_exp_f32 v243, v243
 v_exp_f32 v244, v244
 v_exp_f32 v245, v245
 v_exp_f32 v246, v246
 v_exp_f32 v247, v247
 v_pk_add_f32 v[240:241], v[240:241], 1.0 op_sel_hi:[1,0]
 v_pk_add_f32 v[242:243], v[242:243], 1.0 op_sel_hi:[1,0]
 v_pk_add_f32 v[244:245], v[244:245], 1.0 op_sel_hi:[1,0]
 v_pk_add_f32 v[246:247], v[246:247], 1.0 op_sel_hi:[1,0]
 v_rcp_f32 v240, v240
 v_rcp_f32 v241, v241
 v_rcp_f32 v242, v242
 v_rcp_f32 v243, v243
 v_rcp_f32 v244, v244
 v_rcp_f32 v245, v245
 v_rcp_f32 v246, v246
 v_rcp_f32 v247, v247
 v_pk_mul_f32 v[240:241], v[240:241], v[200:201]
 v_pk_mul_f32 v[242:243], v[242:243], v[202:203]
 v_pk_mul_f32 v[244:245], v[244:245], v[204:205]
 v_pk_mul_f32 v[246:247], v[246:247], v[206:207]
 v_cvt_pk_bf16_f32 v192, v240, v241
 v_cvt_pk_bf16_f32 v193, v242, v243
 v_cvt_pk_bf16_f32 v194, v244, v245
 v_cvt_pk_bf16_f32 v195, v246, v247
 buffer_store_dwordx4 v[192:195], v6, s[48:51], s71 offen offset:3072 sc1
 v_xad_u32 v222, v192, v193, v222
 v_add3_u32 v222, v222, v194, v195
 buffer_store_dword v222, v2, s[48:51], s71 offen sc1
 buffer_store_dword v10, v7, s[48:51], s71 offen sc1
 s_waitcnt lgkmcnt(0)
L_join:
 s_sub_u32 s3, s54, s55
 v_add_u32 v8, s3, v8
 v_add_u32 v255, s3, v255
 v_add_u32 v253, s3, v253
 v_add_u32 v251, s3, v251
 v_xad_u32 v4, v224, v225, s61
 v_add3_u32 v4, v4, v226, v227
 v_xad_u32 v4, v228, v229, v4
 v_add3_u32 v4, v4, v230, v231
 v_xad_u32 v4, v232, v233, v4
 v_add3_u32 v4, v4, v234, v235
 v_xad_u32 v4, v236, v237, v4
 v_add3_u32 v4, v4, v238, v239
 v_cmp_ne_u32 vcc, v4, v212
 s_cbranch_vccnz L_hh0_0_r
L_hh0_0_b:
 v_mfma_f32_16x16x32_bf16 v[48:51], a[0:3], v[224:227], 0
 buffer_load_dwordx4 v[16:19], v6, s[48:51], s21 offen offset:0 sc1
 buffer_load_dwordx4 v[20:23], v6, s[48:51], s21 offen offset:1024 sc1
 v_mfma_f32_16x16x32_bf16 v[52:55], a[0:3], v[228:231], 0
 v_mfma_f32_16x16x32_bf16 v[56:59], a[4:7], v[224:227], 0
 v_mfma_f32_16x16x32_bf16 v[60:63], a[4:7], v[228:231], 0
 v_mfma_f32_16x16x32_bf16 v[64:67], a[8:11], v[224:227], 0
 s_mul_i32 s3, s56, 17408
 buffer_load_dwordx4 v[24:27], v6, s[48:51], s21 offen offset:2048 sc1
 v_mfma_f32_16x16x32_bf16 v[68:71], a[8:11], v[228:231], 0
 v_mfma_f32_16x16x32_bf16 v[72:75], a[12:15], v[224:227], 0
 v_and_b32 v12, 32, v0
 v_xad_u32 v4, v80, v81, s61
 v_mfma_f32_16x16x32_bf16 v[76:79], a[12:15], v[228:231], 0
 v_add3_u32 v4, v4, v82, v83
 v_xad_u32 v4, v84, v85, v4
 v_mfma_f32_16x16x32_bf16 v[48:51], a[16:19], v[232:235], v[48:51]
 v_xor_b32 v12, v12, v6
 v_add3_u32 v4, v4, v86, v87
 v_mfma_f32_16x16x32_bf16 v[52:55], a[16:19], v[236:239], v[52:55]
 v_xad_u32 v4, v88, v89, v4
 v_add3_u32 v4, v4, v90, v91
 v_mfma_f32_16x16x32_bf16 v[56:59], a[20:23], v[232:235], v[56:59]
 v_add_u32 v12, s3, v12
 v_xad_u32 v4, v92, v93, v4
 v_mfma_f32_16x16x32_bf16 v[60:63], a[20:23], v[236:239], v[60:63]
 v_add3_u32 v4, v4, v94, v95
 v_cmp_ne_u32 vcc, v4, v213
 v_mfma_f32_16x16x32_bf16 v[64:67], a[24:27], v[232:235], v[64:67]
 v_and_b32 v15, 6, v0
 buffer_load_dwordx4 v[28:31], v6, s[48:51], s21 offen offset:3072 sc1
 v_mfma_f32_16x16x32_bf16 v[68:71], a[24:27], v[236:239], v[68:71]
 buffer_load_dword v217, v2, s[48:51], s21 offen sc1
 s_barrier
 v_mfma_f32_16x16x32_bf16 v[72:75], a[28:31], v[232:235], v[72:75]
 v_bfe_u32 v13, v0, 3, 1
 s_add_u32 m0, s54, 0
 v_mfma_f32_16x16x32_bf16 v[76:79], a[28:31], v[236:239], v[76:79]
 buffer_load_dwordx4 v254, s[40:43], s85 offen lds
 s_add_u32 m0, s54, 1024
 s_cbranch_vccnz L_hh0_1_r
L_hh0_1_b:
 v_mfma_f32_16x16x32_bf16 v[48:51], a[32:35], v[80:83], v[48:51]
 v_add_u32 v15, v15, v13
 s_add_u32 s100, s85, 8192
 v_mfma_f32_16x16x32_bf16 v[52:55], a[32:35], v[84:87], v[52:55]
 buffer_load_dwordx4 v254, s[40:43], s100 offen lds
 s_add_u32 m0, s54, 2048
 v_mfma_f32_16x16x32_bf16 v[56:59], a[36:39], v[80:83], v[56:59]
 v_mul_u32_u24 v15, 1088, v15
 s_add_u32 s100, s85, 16384
 v_mfma_f32_16x16x32_bf16 v[60:63], a[36:39], v[84:87], v[60:63]
 buffer_load_dwordx4 v254, s[40:43], s100 offen lds
 s_add_u32 m0, s54, 3072
 v_mfma_f32_16x16x32_bf16 v[64:67], a[40:43], v[80:83], v[64:67]
 v_and_b32 v14, 1, v0
 s_add_u32 s100, s85, 24576
 v_mfma_f32_16x16x32_bf16 v[68:71], a[40:43], v[84:87], v[68:71]
 buffer_load_dwordx4 v254, s[40:43], s100 offen lds
 s_add_u32 m0, s54, 4096
 v_mfma_f32_16x16x32_bf16 v[72:75], a[44:47], v[80:83], v[72:75]
 v_lshl_add_u32 v15, v14, 9, v15
 s_waitcnt vmcnt(25)
 v_mfma_f32_16x16x32_bf16 v[76:79], a[44:47], v[84:87], v[76:79]
 v_xad_u32 v4, v96, v97, s61
 v_add3_u32 v4, v4, v98, v99
 v_mfma_f32_16x16x32_bf16 v[48:51], a[48:51], v[88:91], v[48:51]
 v_lshlrev_b32 v14, 1, v14
 v_xad_u32 v4, v100, v101, v4
 v_mfma_f32_16x16x32_bf16 v[52:55], a[48:51], v[92:95], v[52:55]
 v_add3_u32 v4, v4, v102, v103
 v_xad_u32 v4, v104, v105, v4
 v_mfma_f32_16x16x32_bf16 v[56:59], a[52:55], v[88:91], v[56:59]
 v_lshrrev_b32 v13, 4, v0
 v_add3_u32 v4, v4, v106, v107
 v_mfma_f32_16x16x32_bf16 v[60:63], a[52:55], v[92:95], v[60:63]
 v_xad_u32 v4, v108, v109, v4
 v_add3_u32 v4, v4, v110, v111
 v_mfma_f32_16x16x32_bf16 v[64:67], a[56:59], v[88:91], v[64:67]
 v_xor_b32 v13, v13, v14
 v_cmp_ne_u32 vcc, v4, v214
 v_mfma_f32_16x16x32_bf16 v[68:71], a[56:59], v[92:95], v[68:71]
 s_add_u32 s100, s85, 32768
 buffer_load_dwordx4 v254, s[40:43], s100 offen lds
 v_mfma_f32_16x16x32_bf16 v[72:75], a[60:63], v[88:91], v[72:75]
 v_lshl_add_u32 v13, v13, 4, v15
 s_add_u32 m0, s54, 5120
 v_mfma_f32_16x16x32_bf16 v[76:79], a[60:63], v[92:95], v[76:79]
 s_add_u32 s100, s85, 40960
 buffer_load_dwordx4 v254, s[40:43], s100 offen lds
 s_cbranch_vccnz L_hh0_2_r
L_hh0_2_b:
 v_mfma_f32_16x16x32_bf16 v[48:51], a[64:67], v[96:99], v[48:51]
 v_add_u32 v14, 34816, v13
 s_add_u32 m0, s54, 6144
 v_mfma_f32_16x16x32_bf16 v[52:55], a[64:67], v[100:103], v[52:55]
 s_add_u32 s100, s85, 49152
 buffer_load_dwordx4 v254, s[40:43], s100 offen lds
 v_mfma_f32_16x16x32_bf16 v[56:59], a[68:71], v[96:99], v[56:59]
 s_add_u32 m0, s54, 7168
 s_add_u32 s100, s85, 57344
 v_mfma_f32_16x16x32_bf16 v[60:63], a[68:71], v[100:103], v[60:63]
 buffer_load_dwordx4 v254, s[40:43], s100 offen lds
 s_add_u32 m0, s54, 8192
 v_mfma_f32_16x16x32_bf16 v[64:67], a[72:75], v[96:99], v[64:67]
 buffer_load_dwordx4 v254, s[40:43], s86 offen lds
 s_add_u32 m0, s54, 9216
 v_mfma_f32_16x16x32_bf16 v[68:71], a[72:75], v[100:103], v[68:71]
 s_add_u32 s100, s86, 8192
 v_mfma_f32_16x16x32_bf16 v[72:75], a[76:79], v[96:99], v[72:75]
 s_waitcnt vmcnt(25)
 v_xad_u32 v4, v112, v113, s61
 v_mfma_f32_16x16x32_bf16 v[76:79], a[76:79], v[100:103], v[76:79]
 v_add3_u32 v4, v4, v114, v115
 v_xad_u32 v4, v116, v117, v4
 v_mfma_f32_16x16x32_bf16 v[48:51], a[80:83], v[104:107], v[48:51]
 v_add3_u32 v4, v4, v118, v119
 v_xad_u32 v4, v120, v121, v4
 v_mfma_f32_16x16x32_bf16 v[52:55], a[80:83], v[108:111], v[52:55]
 v_add3_u32 v4, v4, v122, v123
 v_xad_u32 v4, v124, v125, v4
 v_mfma_f32_16x16x32_bf16 v[56:59], a[84:87], v[104:107], v[56:59]
 v_add3_u32 v4, v4, v126, v127
 v_cmp_ne_u32 vcc, v4, v215
 v_mfma_f32_16x16x32_bf16 v[60:63], a[84:87], v[108:111], v[60:63]
 buffer_load_dwordx4 v254, s[40:43], s100 offen lds
 s_add_u32 m0, s54, 10240
 v_mfma_f32_16x16x32_bf16 v[64:67], a[88:91], v[104:107], v[64:67]
 s_add_u32 s100, s86, 16384
 buffer_load_dwordx4 v254, s[40:43], s100 offen lds
 v_mfma_f32_16x16x32_bf16 v[68:71], a[88:91], v[108:111], v[68:71]
 s_add_u32 m0, s54, 11264
 s_add_u32 s100, s86, 24576
 v_mfma_f32_16x16x32_bf16 v[72:75], a[92:95], v[104:107], v[72:75]
 buffer_load_dwordx4 v254, s[40:43], s100 offen lds
 s_add_u32 m0, s54, 12288
 v_mfma_f32_16x16x32_bf16 v[76:79], a[92:95], v[108:111], v[76:79]
 s_add_u32 s100, s86, 32768
 s_cbranch_vccnz L_hh0_3_r
L_hh0_3_b:
 v_mfma_f32_16x16x32_bf16 v[48:51], a[96:99], v[112:115], v[48:51]
 buffer_load_dwordx4 v254, s[40:43], s100 offen lds
 s_add_u32 m0, s54, 13312
 v_mfma_f32_16x16x32_bf16 v[52:55], a[96:99], v[116:119], v[52:55]
 s_add_u32 s100, s86, 40960
 v_mfma_f32_16x16x32_bf16 v[56:59], a[100:103], v[112:115], v[56:59]
 buffer_load_dwordx4 v254, s[40:43], s100 offen lds
 s_add_u32 m0, s54, 14336
 v_mfma_f32_16x16x32_bf16 v[60:63], a[100:103], v[116:119], v[60:63]
 s_add_u32 s100, s86, 49152
 v_mfma_f32_16x16x32_bf16 v[64:67], a[104:107], v[112:115], v[64:67]
 buffer_load_dwordx4 v254, s[40:43], s100 offen lds
 s_add_u32 m0, s54, 15360
 v_mfma_f32_16x16x32_bf16 v[68:71], a[104:107], v[116:119], v[68:71]
 s_add_u32 s100, s86, 57344
 v_mfma_f32_16x16x32_bf16 v[72:75], a[108:111], v[112:115], v[72:75]
 s_waitcnt vmcnt(26)
 v_xad_u32 v4, v128, v129, s61
 v_mfma_f32_16x16x32_bf16 v[76:79], a[108:111], v[116:119], v[76:79]
 v_add3_u32 v4, v4, v130, v131
 v_xad_u32 v4, v132, v133, v4
 buffer_load_dwordx4 v254, s[40:43], s100 offen lds
 v_mfma_f32_16x16x32_bf16 v[48:51], a[112:115], v[120:123], v[48:51]
 v_add3_u32 v4, v4, v134, v135
 v_xad_u32 v4, v136, v137, v4
 v_mfma_f32_16x16x32_bf16 v[52:55], a[112:115], v[124:127], v[52:55]
 v_add3_u32 v4, v4, v138, v139
 v_xad_u32 v4, v140, v141, v4
 v_mfma_f32_16x16x32_bf16 v[56:59], a[116:119], v[120:123], v[56:59]
 v_add3_u32 v4, v4, v142, v143
 v_cmp_ne_u32 vcc, v4, v216
 v_mfma_f32_16x16x32_bf16 v[60:63], a[116:119], v[124:127], v[60:63]
 buffer_load_dwordx4 v[32:35], v6, s[48:51], s22 offen offset:0 sc1
 buffer_load_dwordx4 v[36:39], v6, s[48:51], s22 offen offset:1024 sc1
 v_mfma_f32_16x16x32_bf16 v[64:67], a[120:123], v[120:123], v[64:67]
 s_waitcnt vmcnt(14)
 ds_read_b64_tr_b16 a[160:161], v8 offset:0
 v_mfma_f32_16x16x32_bf16 v[68:71], a[120:123], v[124:127], v[68:71]
 ds_read_b64_tr_b16 a[164:165], v255 offset:0
 ds_read_b64_tr_b16 a[168:169], v253 offset:0
 v_mfma_f32_16x16x32_bf16 v[72:75], a[124:127], v[120:123], v[72:75]
 buffer_load_dwordx4 v[40:43], v6, s[48:51], s22 offen offset:2048 sc1
 ds_read_b64_tr_b16 a[172:173], v251 offset:0
 v_mfma_f32_16x16x32_bf16 v[76:79], a[124:127], v[124:127], v[76:79]
 ds_read_b64_tr_b16 a[162:163], v8 offset:2048
 ds_read_b64_tr_b16 a[166:167], v255 offset:2048
 s_cbranch_vccnz L_hh0_4_r
L_hh0_4_b:
 v_mfma_f32_16x16x32_bf16 v[48:51], a[128:131], v[128:131], v[48:51]
 buffer_load_dwordx4 v[44:47], v6, s[48:51], s22 offen offset:3072 sc1
 buffer_load_dword v218, v2, s[48:51], s22 offen sc1
 v_mfma_f32_16x16x32_bf16 v[52:55], a[128:131], v[132:135], v[52:55]
 ds_read_b64_tr_b16 a[170:171], v253 offset:2048
 ds_read_b64_tr_b16 a[174:175], v251 offset:2048
 v_mfma_f32_16x16x32_bf16 v[56:59], a[132:135], v[128:131], v[56:59]
 s_waitcnt vmcnt(13)
 ds_read_b64_tr_b16 a[176:177], v8 offset:4096
 v_mfma_f32_16x16x32_bf16 v[60:63], a[132:135], v[132:135], v[60:63]
 ds_read_b64_tr_b16 a[180:181], v255 offset:4096
 ds_read_b64_tr_b16 a[184:185], v253 offset:4096
 v_mfma_f32_16x16x32_bf16 v[64:67], a[136:139], v[128:131], v[64:67]
 ds_read_b64_tr_b16 a[188:189], v251 offset:4096
 ds_read_b64_tr_b16 a[178:179], v8 offset:6144
 v_mfma_f32_16x16x32_bf16 v[68:71], a[136:139], v[132:135], v[68:71]
 ds_read_b64_tr_b16 a[182:183], v255 offset:6144
 ds_read_b64_tr_b16 a[186:187], v253 offset:6144
 v_mfma_f32_16x16x32_bf16 v[72:75], a[140:143], v[128:131], v[72:75]
 v_xad_u32 v4, v16, v17, s61
 v_add3_u32 v4, v4, v18, v19
 v_mfma_f32_16x16x32_bf16 v[76:79], a[140:143], v[132:135], v[76:79]
 v_xad_u32 v4, v20, v21, v4
 v_add3_u32 v4, v4, v22, v23
 v_mfma_f32_16x16x32_bf16 v[48:51], a[144:147], v[136:139], v[48:51]
 v_xad_u32 v4, v24, v25, v4
 v_add3_u32 v4, v4, v26, v27
 v_mfma_f32_16x16x32_bf16 v[52:55], a[144:147], v[140:143], v[52:55]
 v_xad_u32 v4, v28, v29, v4
 v_add3_u32 v4, v4, v30, v31
 v_mfma_f32_16x16x32_bf16 v[56:59], a[148:151], v[136:139], v[56:59]
 v_cmp_ne_u32 vcc, v4, v217
 ds_read_b64_tr_b16 a[190:191], v251 offset:6144
 v_mfma_f32_16x16x32_bf16 v[60:63], a[148:151], v[140:143], v[60:63]
 s_waitcnt vmcnt(9)
 ds_read_b64_tr_b16 a[192:193], v8 offset:8192
 v_mfma_f32_16x16x32_bf16 v[64:67], a[152:155], v[136:139], v[64:67]
 ds_read_b64_tr_b16 a[196:197], v255 offset:8192
 ds_read_b64_tr_b16 a[200:201], v253 offset:8192
 v_mfma_f32_16x16x32_bf16 v[68:71], a[152:155], v[140:143], v[68:71]
 ds_read_b64_tr_b16 a[204:205], v251 offset:8192
 ds_read_b64_tr_b16 a[194:195], v8 offset:10240
 v_mfma_f32_16x16x32_bf16 v[72:75], a[156:159], v[136:139], v[72:75]
 ds_read_b64_tr_b16 a[198:199], v255 offset:10240
 ds_read_b64_tr_b16 a[202:203], v253 offset:10240
 v_mfma_f32_16x16x32_bf16 v[76:79], a[156:159], v[140:143], v[76:79]
 ds_read_b64_tr_b16 a[206:207], v251 offset:10240
 s_waitcnt vmcnt(5)
 s_cbranch_vccnz L_hh0_5_r
L_hh0_5_b:
 ds_read_b64_tr_b16 a[208:209], v8 offset:12288
 ds_read_b64_tr_b16 a[212:213], v255 offset:12288
 ds_read_b64_tr_b16 a[216:217], v253 offset:12288
 ds_read_b64_tr_b16 a[220:221], v251 offset:12288
 ds_read_b64_tr_b16 a[210:211], v8 offset:14336
 ds_read_b64_tr_b16 a[214:215], v255 offset:14336
 ds_read_b64_tr_b16 a[218:219], v253 offset:14336
 ds_read_b64_tr_b16 a[222:223], v251 offset:14336
 s_waitcnt lgkmcnt(0)
 v_mfma_f32_16x16x32_bf16 v[48:51], a[160:163], v[16:19], v[48:51]
 s_cmp_ge_u32 s67, 7
 s_cbranch_scc1 L_ip1
L_ip1b:
 buffer_load_dwordx4 v[144:147], v6, s[48:51], s23 offen offset:0 sc1
 v_mfma_f32_16x16x32_bf16 v[52:55], a[160:163], v[20:23], v[52:55]
 buffer_load_dwordx4 v[148:151], v6, s[48:51], s23 offen offset:1024 sc1
 v_mfma_f32_16x16x32_bf16 v[56:59], a[164:167], v[16:19], v[56:59]
 v_mfma_f32_16x16x32_bf16 v[60:63], a[164:167], v[20:23], v[60:63]
 v_mfma_f32_16x16x32_bf16 v[64:67], a[168:171], v[16:19], v[64:67]
 buffer_load_dwordx4 v[152:155], v6, s[48:51], s23 offen offset:2048 sc1
 v_mfma_f32_16x16x32_bf16 v[68:71], a[168:171], v[20:23], v[68:71]
 v_mfma_f32_16x16x32_bf16 v[72:75], a[172:175], v[16:19], v[72:75]
 s_waitcnt vmcnt(3)
 v_xad_u32 v4, v32, v33, s61
 v_mfma_f32_16x16x32_bf16 v[76:79], a[172:175], v[20:23], v[76:79]
 v_add3_u32 v4, v4, v34, v35
 v_xad_u32 v4, v36, v37, v4
 v_mfma_f32_16x16x32_bf16 v[48:51], a[176:179], v[24:27], v[48:51]
 v_add3_u32 v4, v4, v38, v39
 v_xad_u32 v4, v40, v41, v4
 v_mfma_f32_16x16x32_bf16 v[52:55], a[176:179], v[28:31], v[52:55]
 v_add3_u32 v4, v4, v42, v43
 v_xad_u32 v4, v44, v45, v4
 v_mfma_f32_16x16x32_bf16 v[56:59], a[180:183], v[24:27], v[56:59]
 v_add3_u32 v4, v4, v46, v47
 v_cmp_ne_u32 vcc, v4, v218
 v_mfma_f32_16x16x32_bf16 v[60:63], a[180:183], v[28:31], v[60:63]
 buffer_load_dwordx4 v[156:159], v6, s[48:51], s23 offen offset:3072 sc1
 buffer_load_dword v208, v2, s[48:51], s23 offen sc1
 v_mfma_f32_16x16x32_bf16 v[64:67], a[184:187], v[24:27], v[64:67]
 buffer_load_dwordx4 v[160:163], v6, s[48:51], s24 offen offset:0 sc1
 v_mfma_f32_16x16x32_bf16 v[68:71], a[184:187], v[28:31], v[68:71]
 v_mfma_f32_16x16x32_bf16 v[72:75], a[188:191], v[24:27], v[72:75]
 buffer_load_dwordx4 v[164:167], v6, s[48:51], s24 offen offset:1024 sc1
 v_mfma_f32_16x16x32_bf16 v[76:79], a[188:191], v[28:31], v[76:79]
 s_cbranch_vccnz L_hh0_6_r
L_hh0_6_b:
 v_mfma_f32_16x16x32_bf16 v[48:51], a[192:195], v[32:35], v[48:51]
 buffer_load_dwordx4 v[168:171], v6, s[48:51], s24 offen offset:2048 sc1
 v_mfma_f32_16x16x32_bf16 v[52:55], a[192:195], v[36:39], v[52:55]
 v_mfma_f32_16x16x32_bf16 v[56:59], a[196:199], v[32:35], v[56:59]
 buffer_load_dwordx4 v[172:175], v6, s[48:51], s24 offen offset:3072 sc1
 v_mfma_f32_16x16x32_bf16 v[60:63], a[196:199], v[36:39], v[60:63]
 v_mfma_f32_16x16x32_bf16 v[64:67], a[200:203], v[32:35], v[64:67]
 buffer_load_dword v209, v2, s[48:51], s24 offen sc1
 v_mfma_f32_16x16x32_bf16 v[68:71], a[200:203], v[36:39], v[68:71]
 v_mfma_f32_16x16x32_bf16 v[72:75], a[204:207], v[32:35], v[72:75]
 buffer_load_dwordx4 v[176:179], v6, s[48:51], s25 offen offset:0 sc1
 buffer_load_dwordx4 v[180:183], v6, s[48:51], s25 offen offset:1024 sc1
 buffer_load_dwordx4 v[184:187], v6, s[48:51], s25 offen offset:2048 sc1
 buffer_load_dwordx4 v[188:191], v6, s[48:51], s25 offen offset:3072 sc1
 buffer_load_dword v210, v2, s[48:51], s25 offen sc1
 s_waitcnt vmcnt(10)
 v_xad_u32 v4, v144, v145, s61
 v_mfma_f32_16x16x32_bf16 v[76:79], a[204:207], v[36:39], v[76:79]
 v_add3_u32 v4, v4, v146, v147
 v_xad_u32 v4, v148, v149, v4
 v_mfma_f32_16x16x32_bf16 v[48:51], a[208:211], v[40:43], v[48:51]
 v_add3_u32 v4, v4, v150, v151
 v_xad_u32 v4, v152, v153, v4
 v_mfma_f32_16x16x32_bf16 v[52:55], a[208:211], v[44:47], v[52:55]
 v_add3_u32 v4, v4, v154, v155
 v_xad_u32 v4, v156, v157, v4
 v_mfma_f32_16x16x32_bf16 v[56:59], a[212:215], v[40:43], v[56:59]
 v_add3_u32 v4, v4, v158, v159
 v_cmp_ne_u32 vcc, v4, v208
 v_mfma_f32_16x16x32_bf16 v[60:63], a[212:215], v[44:47], v[60:63]
 buffer_load_dwordx4 v[192:195], v6, s[48:51], s26 offen offset:0 sc1
 buffer_load_dwordx4 v[196:199], v6, s[48:51], s26 offen offset:1024 sc1
 v_mfma_f32_16x16x32_bf16 v[64:67], a[216:219], v[40:43], v[64:67]
 v_mfma_f32_16x16x32_bf16 v[68:71], a[216:219], v[44:47], v[68:71]
 v_mfma_f32_16x16x32_bf16 v[72:75], a[220:223], v[40:43], v[72:75]
 buffer_load_dwordx4 v[200:203], v6, s[48:51], s26 offen offset:2048 sc1
 v_mfma_f32_16x16x32_bf16 v[76:79], a[220:223], v[44:47], v[76:79]
 s_cbranch_vccnz L_hh1_0_r
L_hh1_0_b:
 v_mfma_f32_16x16x32_bf16 v[16:19], a[0:3], v[144:147], 0
 s_barrier
 buffer_load_dwordx4 v[204:207], v6, s[48:51], s26 offen offset:3072 sc1
 v_mfma_f32_16x16x32_bf16 v[20:23], a[0:3], v[148:151], 0
 buffer_load_dword v211, v2, s[48:51], s26 offen sc1
 v_cmp_ne_u32 vcc, s61, v3
 s_nop 0
 s_and_b64 vcc, vcc, 3
 s_cbranch_vccnz L_flag_r
L_flag_b:
 v_mfma_f32_16x16x32_bf16 v[24:27], a[4:7], v[144:147], 0
 buffer_load_dwordx4 v[240:243], v9, s[48:51], s76 offen sc1
 v_mfma_f32_16x16x32_bf16 v[28:31], a[4:7], v[148:151], 0
 v_mfma_f32_16x16x32_bf16 v[32:35], a[8:11], v[144:147], 0
 ds_write_b128 v12, v[48:51] offset:0
 buffer_load_dwordx4 v[244:247], v9, s[48:51], s77 offen sc1
 v_mfma_f32_16x16x32_bf16 v[36:39], a[8:11], v[148:151], 0
 v_mfma_f32_16x16x32_bf16 v[40:43], a[12:15], v[144:147], 0
 s_waitcnt vmcnt(12)
 v_xad_u32 v4, v160, v161, s61
 v_mfma_f32_16x16x32_bf16 v[44:47], a[12:15], v[148:151], 0
 v_add3_u32 v4, v4, v162, v163
 v_xad_u32 v4, v164, v165, v4
 v_mfma_f32_16x16x32_bf16 v[16:19], a[16:19], v[152:155], v[16:19]
 ds_write_b128 v12, v[52:55] offset:1088
 v_add3_u32 v4, v4, v166, v167
 v_mfma_f32_16x16x32_bf16 v[20:23], a[16:19], v[156:159], v[20:23]
 v_xad_u32 v4, v168, v169, v4
 v_add3_u32 v4, v4, v170, v171
 v_mfma_f32_16x16x32_bf16 v[24:27], a[20:23], v[152:155], v[24:27]
 v_xad_u32 v4, v172, v173, v4
 v_add3_u32 v4, v4, v174, v175
 v_mfma_f32_16x16x32_bf16 v[28:31], a[20:23], v[156:159], v[28:31]
 v_cmp_ne_u32 vcc, v4, v209
 buffer_load_dwordx4 v[224:227], v6, s[48:51], s27 offen offset:0 sc1
 v_mfma_f32_16x16x32_bf16 v[32:35], a[24:27], v[152:155], v[32:35]
 ds_write_b128 v12, v[56:59] offset:2176
 buffer_load_dwordx4 v[228:231], v6, s[48:51], s27 offen offset:1024 sc1
 v_mfma_f32_16x16x32_bf16 v[36:39], a[24:27], v[156:159], v[36:39]
 v_mfma_f32_16x16x32_bf16 v[40:43], a[28:31], v[152:155], v[40:43]
 buffer_load_dwordx4 v[232:235], v6, s[48:51], s27 offen offset:2048 sc1
 v_mfma_f32_16x16x32_bf16 v[44:47], a[28:31], v[156:159], v[44:47]
 s_cbranch_vccnz L_hh1_1_r
L_hh1_1_b:
 v_mfma_f32_16x16x32_bf16 v[16:19], a[32:35], v[160:163], v[16:19]
 ds_write_b128 v12, v[60:63] offset:3264
 buffer_load_dwordx4 v[236:239], v6, s[48:51], s27 offen offset:3072 sc1
 v_mfma_f32_16x16x32_bf16 v[20:23], a[32:35], v[164:167], v[20:23]
 buffer_load_dword v219, v2, s[48:51], s27 offen sc1
 v_mfma_f32_16x16x32_bf16 v[24:27], a[36:39], v[160:163], v[24:27]
 buffer_load_dwordx4 v[80:83], v6, s[48:51], s28 offen offset:0 sc1
 v_mfma_f32_16x16x32_bf16 v[28:31], a[36:39], v[164:167], v[28:31]
 v_mfma_f32_16x16x32_bf16 v[32:35], a[40:43], v[160:163], v[32:35]
 ds_write_b128 v12, v[64:67] offset:4352
 v_mfma_f32_16x16x32_bf16 v[36:39], a[40:43], v[164:167], v[36:39]
 v_mfma_f32_16x16x32_bf16 v[40:43], a[44:47], v[160:163], v[40:43]
 s_waitcnt vmcnt(13)
 v_xad_u32 v4, v176, v177, s61
 v_mfma_f32_16x16x32_bf16 v[44:47], a[44:47], v[164:167], v[44:47]
 v_add3_u32 v4, v4, v178, v179
 v_xad_u32 v4, v180, v181, v4
 v_mfma_f32_16x16x32_bf16 v[16:19], a[48:51], v[168:171], v[16:19]
 ds_write_b128 v12, v[68:71] offset:5440
 v_add3_u32 v4, v4, v182, v183
 v_mfma_f32_16x16x32_bf16 v[20:23], a[48:51], v[172:175], v[20:23]
 v_xad_u32 v4, v184, v185, v4
 v_add3_u32 v4, v4, v186, v187
 v_mfma_f32_16x16x32_bf16 v[24:27], a[52:55], v[168:171], v[24:27]
 v_xad_u32 v4, v188, v189, v4
 v_add3_u32 v4, v4, v190, v191
 v_mfma_f32_16x16x32_bf16 v[28:31], a[52:55], v[172:175], v[28:31]
 v_cmp_ne_u32 vcc, v4, v210
 buffer_load_dwordx4 v[84:87], v6, s[48:51], s28 offen offset:1024 sc1
 v_mfma_f32_16x16x32_bf16 v[32:35], a[56:59], v[168:171], v[32:35]
 ds_write_b128 v12, v[72:75] offset:6528
 buffer_load_dwordx4 v[88:91], v6, s[48:51], s28 offen offset:2048 sc1
 v_mfma_f32_16x16x32_bf16 v[36:39], a[56:59], v[172:175], v[36:39]
 v_mfma_f32_16x16x32_bf16 v[40:43], a[60:63], v[168:171], v[40:43]
 buffer_load_dwordx4 v[92:95], v6, s[48:51], s28 offen offset:3072 sc1
 buffer_load_dword v248, v2, s[48:51], s28 offen sc1
 v_mfma_f32_16x16x32_bf16 v[44:47], a[60:63], v[172:175], v[44:47]
 s_cbranch_vccnz L_hh1_2_r
L_hh1_2_b:
 v_mfma_f32_16x16x32_bf16 v[16:19], a[64:67], v[176:179], v[16:19]
 ds_write_b128 v12, v[76:79] offset:7616
 buffer_load_dwordx4 v[96:99], v6, s[48:51], s29 offen offset:0 sc1
 v_mfma_f32_16x16x32_bf16 v[20:23], a[64:67], v[180:183], v[20:23]
 v_mfma_f32_16x16x32_bf16 v[24:27], a[68:71], v[176:179], v[24:27]
 buffer_load_dwordx4 v[100:103], v6, s[48:51], s29 offen offset:1024 sc1
 v_mfma_f32_16x16x32_bf16 v[28:31], a[68:71], v[180:183], v[28:31]
 v_mfma_f32_16x16x32_bf16 v[32:35], a[72:75], v[176:179], v[32:35]
 v_mfma_f32_16x16x32_bf16 v[36:39], a[72:75], v[180:183], v[36:39]
 v_mfma_f32_16x16x32_bf16 v[40:43], a[76:79], v[176:179], v[40:43]
 s_waitcnt vmcnt(14)
 v_xad_u32 v4, v192, v193, s61
 v_mfma_f32_16x16x32_bf16 v[44:47], a[76:79], v[180:183], v[44:47]
 v_add3_u32 v4, v4, v194, v195
 v_xad_u32 v4, v196, v197, v4
 v_mfma_f32_16x16x32_bf16 v[16:19], a[80:83], v[184:187], v[16:19]
 s_waitcnt lgkmcnt(0)
 s_barrier
 v_mfma_f32_16x16x32_bf16 v[20:23], a[80:83], v[188:191], v[20:23]
 v_add3_u32 v4, v4, v198, v199
 v_xad_u32 v4, v200, v201, v4
 v_mfma_f32_16x16x32_bf16 v[24:27], a[84:87], v[184:187], v[24:27]
 ds_read_b128 v[112:115], v13 offset:0
 ds_read_b128 v[116:119], v13 offset:256
 v_mfma_f32_16x16x32_bf16 v[28:31], a[84:87], v[188:191], v[28:31]
 v_add3_u32 v4, v4, v202, v203
 v_xad_u32 v4, v204, v205, v4
 v_mfma_f32_16x16x32_bf16 v[32:35], a[88:91], v[184:187], v[32:35]
 ds_read_b128 v[120:123], v13 offset:17408
 ds_read_b128 v[124:127], v13 offset:17664
 v_mfma_f32_16x16x32_bf16 v[36:39], a[88:91], v[188:191], v[36:39]
 v_add3_u32 v4, v4, v206, v207
 v_cmp_ne_u32 vcc, v4, v211
 v_mfma_f32_16x16x32_bf16 v[40:43], a[92:95], v[184:187], v[40:43]
 ds_read_b128 v[128:131], v14 offset:0
 ds_read_b128 v[132:135], v14 offset:256
 v_mfma_f32_16x16x32_bf16 v[44:47], a[92:95], v[188:191], v[44:47]
 buffer_load_dwordx4 v[104:107], v6, s[48:51], s29 offen offset:2048 sc1
 buffer_load_dwordx4 v[108:111], v6, s[48:51], s29 offen offset:3072 sc1
 s_cbranch_vccnz L_hh1_3_r
L_hh1_3_b:
 v_mfma_f32_16x16x32_bf16 v[16:19], a[96:99], v[192:195], v[16:19]
 ds_read_b128 v[136:139], v14 offset:17408
 ds_read_b128 v[140:143], v14 offset:17664
 v_mfma_f32_16x16x32_bf16 v[20:23], a[96:99], v[196:199], v[20:23]
 buffer_load_dword v212, v2, s[48:51], s29 offen sc1
 v_mfma_f32_16x16x32_bf16 v[24:27], a[100:103], v[192:195], v[24:27]
 s_waitcnt vmcnt(15)
 v_lshlrev_b32 v48, 16, v240
 v_mfma_f32_16x16x32_bf16 v[28:31], a[100:103], v[196:199], v[28:31]
 v_and_b32 v49, s64, v240
 v_lshlrev_b32 v50, 16, v241
 v_mfma_f32_16x16x32_bf16 v[32:35], a[104:107], v[192:195], v[32:35]
 v_and_b32 v51, s64, v241
 v_lshlrev_b32 v52, 16, v242
 v_mfma_f32_16x16x32_bf16 v[36:39], a[104:107], v[196:199], v[36:39]
 v_and_b32 v53, s64, v242
 v_lshlrev_b32 v54, 16, v243
 v_mfma_f32_16x16x32_bf16 v[40:43], a[108:111], v[192:195], v[40:43]
 s_waitcnt vmcnt(10)
 v_xad_u32 v4, v224, v225, s61
 v_mfma_f32_16x16x32_bf16 v[44:47], a[108:111], v[196:199], v[44:47]
 v_add3_u32 v4, v4, v226, v227
 v_xad_u32 v4, v228, v229, v4
 v_mfma_f32_16x16x32_bf16 v[16:19], a[112:115], v[200:203], v[16:19]
 v_add3_u32 v4, v4, v230, v231
 v_xad_u32 v4, v232, v233, v4
 v_mfma_f32_16x16x32_bf16 v[20:23], a[112:115], v[204:207], v[20:23]
 v_add3_u32 v4, v4, v234, v235
 v_xad_u32 v4, v236, v237, v4
 v_mfma_f32_16x16x32_bf16 v[24:27], a[116:119], v[200:203], v[24:27]
 v_add3_u32 v4, v4, v238, v239
 v_cmp_ne_u32 vcc, v4, v219
 v_mfma_f32_16x16x32_bf16 v[28:31], a[116:119], v[204:207], v[28:31]
 v_and_b32 v55, s64, v243
 v_lshlrev_b32 v56, 16, v244
 v_mfma_f32_16x16x32_bf16 v[32:35], a[120:123], v[200:203], v[32:35]
 v_and_b32 v57, s64, v244
 v_lshlrev_b32 v58, 16, v245
 v_mfma_f32_16x16x32_bf16 v[36:39], a[120:123], v[204:207], v[36:39]
 v_and_b32 v59, s64, v245
 v_lshlrev_b32 v60, 16, v246
 v_mfma_f32_16x16x32_bf16 v[40:43], a[124:127], v[200:203], v[40:43]
 v_and_b32 v61, s64, v246
 v_lshlrev_b32 v62, 16, v247
 v_mfma_f32_16x16x32_bf16 v[44:47], a[124:127], v[204:207], v[44:47]
 v_and_b32 v63, s64, v247
 s_waitcnt lgkmcnt(0)
 s_cbranch_vccnz L_hh1_4_r
L_hh1_4_b:
 v_mfma_f32_16x16x32_bf16 v[16:19], a[128:131], v[224:227], v[16:19]
 v_add_f32 v112, v112, v120
 v_add_f32 v113, v113, v121
 v_mfma_f32_16x16x32_bf16 v[20:23], a[128:131], v[228:231], v[20:23]
 v_add_f32 v114, v114, v122
 v_add_f32 v115, v115, v123
 v_mfma_f32_16x16x32_bf16 v[24:27], a[132:135], v[224:227], v[24:27]
 v_add_f32 v116, v116, v124
 v_add_f32 v117, v117, v125
 v_mfma_f32_16x16x32_bf16 v[28:31], a[132:135], v[228:231], v[28:31]
 v_add_f32 v118, v118, v126
 v_add_f32 v119, v119, v127
 v_mfma_f32_16x16x32_bf16 v[32:35], a[136:139], v[224:227], v[32:35]
 v_add_f32 v128, v128, v136
 v_add_f32 v129, v129, v137
 v_mfma_f32_16x16x32_bf16 v[36:39], a[136:139], v[228:231], v[36:39]
 v_add_f32 v130, v130, v138
 v_add_f32 v131, v131, v139
 v_mfma_f32_16x16x32_bf16 v[40:43], a[140:143], v[224:227], v[40:43]
 s_waitcnt vmcnt(5)
 v_xad_u32 v4, v80, v81, s61
 v_mfma_f32_16x16x32_bf16 v[44:47], a[140:143], v[228:231], v[44:47]
 v_add3_u32 v4, v4, v82, v83
 v_xad_u32 v4, v84, v85, v4
 v_mfma_f32_16x16x32_bf16 v[16:19], a[144:147], v[232:235], v[16:19]
 v_add3_u32 v4, v4, v86, v87
 v_xad_u32 v4, v88, v89, v4
 v_mfma_f32_16x16x32_bf16 v[20:23], a[144:147], v[236:239], v[20:23]
 v_add3_u32 v4, v4, v90, v91
 v_xad_u32 v4, v92, v93, v4
 v_mfma_f32_16x16x32_bf16 v[24:27], a[148:151], v[232:235], v[24:27]
 v_add3_u32 v4, v4, v94, v95
 v_cmp_ne_u32 vcc, v4, v248
 v_mfma_f32_16x16x32_bf16 v[28:31], a[148:151], v[236:239], v[28:31]
 v_add_f32 v132, v132, v140
 v_add_f32 v133, v133, v141
 v_mfma_f32_16x16x32_bf16 v[32:35], a[152:155], v[232:235], v[32:35]
 v_add_f32 v134, v134, v142
 v_add_f32 v135, v135, v143
 v_mfma_f32_16x16x32_bf16 v[36:39], a[152:155], v[236:239], v[36:39]
 v_add_f32 v112, v112, v48
 v_add_f32 v113, v113, v49
 v_mfma_f32_16x16x32_bf16 v[40:43], a[156:159], v[232:235], v[40:43]
 v_add_f32 v114, v114, v50
 v_add_f32 v115, v115, v51
 v_mfma_f32_16x16x32_bf16 v[44:47], a[156:159], v[236:239], v[44:47]
 v_add_f32 v116, v116, v52
 v_add_f32 v117, v117, v53
 s_cbranch_vccnz L_hh1_5_r
L_hh1_5_b:
 v_mfma_f32_16x16x32_bf16 v[16:19], a[160:163], v[80:83], v[16:19]
 v_add_f32 v118, v118, v54
 v_add_f32 v119, v119, v55
 v_mfma_f32_16x16x32_bf16 v[20:23], a[160:163], v[84:87], v[20:23]
 v_add_f32 v112, v112, v128
 v_add_f32 v113, v113, v129
 v_mfma_f32_16x16x32_bf16 v[24:27], a[164:167], v[80:83], v[24:27]
 v_add_f32 v114, v114, v130
 v_add_f32 v115, v115, v131
 v_mfma_f32_16x16x32_bf16 v[28:31], a[164:167], v[84:87], v[28:31]
 v_add_f32 v116, v116, v132
 v_add_f32 v117, v117, v133
 v_mfma_f32_16x16x32_bf16 v[32:35], a[168:171], v[80:83], v[32:35]
 v_add_f32 v118, v118, v134
 v_add_f32 v119, v119, v135
 v_mfma_f32_16x16x32_bf16 v[36:39], a[168:171], v[84:87], v[36:39]
 v_cvt_pk_bf16_f32 v128, v112, v113
 v_cvt_pk_bf16_f32 v129, v114, v115
 v_mfma_f32_16x16x32_bf16 v[40:43], a[172:175], v[80:83], v[40:43]
 s_waitcnt vmcnt(0)
 v_xad_u32 v4, v96, v97, s61
 v_mfma_f32_16x16x32_bf16 v[44:47], a[172:175], v[84:87], v[44:47]
 v_add3_u32 v4, v4, v98, v99
 v_xad_u32 v4, v100, v101, v4
 v_mfma_f32_16x16x32_bf16 v[16:19], a[176:179], v[88:91], v[16:19]
 v_add3_u32 v4, v4, v102, v103
 v_xad_u32 v4, v104, v105, v4
 v_mfma_f32_16x16x32_bf16 v[20:23], a[176:179], v[92:95], v[20:23]
 v_add3_u32 v4, v4, v106, v107
 v_xad_u32 v4, v108, v109, v4
 v_mfma_f32_16x16x32_bf16 v[24:27], a[180:183], v[88:91], v[24:27]
 v_add3_u32 v4, v4, v110, v111
 v_cmp_ne_u32 vcc, v4, v212
 v_mfma_f32_16x16x32_bf16 v[28:31], a[180:183], v[92:95], v[28:31]
 v_cvt_pk_bf16_f32 v130, v116, v117
 v_cvt_pk_bf16_f32 v131, v118, v119
 v_mfma_f32_16x16x32_bf16 v[32:35], a[184:187], v[88:91], v[32:35]
 buffer_store_dwordx4 v[128:131], v9, s[44:47], s68 offen
 v_mfma_f32_16x16x32_bf16 v[36:39], a[184:187], v[92:95], v[36:39]
 v_mfma_f32_16x16x32_bf16 v[40:43], a[188:191], v[88:91], v[40:43]
 v_mfma_f32_16x16x32_bf16 v[44:47], a[188:191], v[92:95], v[44:47]
 s_cbranch_vccnz L_hh1_6_r
L_hh1_6_b:
 v_mfma_f32_16x16x32_bf16 v[16:19], a[192:195], v[96:99], v[16:19]
 v_mfma_f32_16x16x32_bf16 v[20:23], a[192:195], v[100:103], v[20:23]
 v_mfma_f32_16x16x32_bf16 v[24:27], a[196:199], v[96:99], v[24:27]
 v_mfma_f32_16x16x32_bf16 v[28:31], a[196:199], v[100:103], v[28:31]
 v_mfma_f32_16x16x32_bf16 v[32:35], a[200:203], v[96:99], v[32:35]
 v_mfma_f32_16x16x32_bf16 v[36:39], a[200:203], v[100:103], v[36:39]
 v_mfma_f32_16x16x32_bf16 v[40:43], a[204:207], v[96:99], v[40:43]
 v_mfma_f32_16x16x32_bf16 v[44:47], a[204:207], v[100:103], v[44:47]
 v_mfma_f32_16x16x32_bf16 v[16:19], a[208:211], v[104:107], v[16:19]
 v_mfma_f32_16x16x32_bf16 v[20:23], a[208:211], v[108:111], v[20:23]
 v_mfma_f32_16x16x32_bf16 v[24:27], a[212:215], v[104:107], v[24:27]
 v_mfma_f32_16x16x32_bf16 v[28:31], a[212:215], v[108:111], v[28:31]
 v_mfma_f32_16x16x32_bf16 v[32:35], a[216:219], v[104:107], v[32:35]
 v_mfma_f32_16x16x32_bf16 v[36:39], a[216:219], v[108:111], v[36:39]
 v_mfma_f32_16x16x32_bf16 v[40:43], a[220:223], v[104:107], v[40:43]
 v_mfma_f32_16x16x32_bf16 v[44:47], a[220:223], v[108:111], v[44:47]
 s_nop 0
 ds_write_b128 v12, v[16:19] offset:8704
 ds_write_b128 v12, v[20:23] offset:9792
 ds_write_b128 v12, v[24:27] offset:10880
 ds_write_b128 v12, v[28:31] offset:11968
 ds_write_b128 v12, v[32:35] offset:13056
 ds_write_b128 v12, v[36:39] offset:14144
 ds_write_b128 v12, v[40:43] offset:15232
 ds_write_b128 v12, v[44:47] offset:16320
 s_waitcnt lgkmcnt(0)
 s_barrier
 ds_read_b128 v[144:147], v13 offset:8704
 ds_read_b128 v[148:151], v13 offset:8960
 ds_read_b128 v[152:155], v13 offset:26112
 ds_read_b128 v[156:159], v13 offset:26368
 ds_read_b128 v[160:163], v14 offset:8704
 ds_read_b128 v[164:167], v14 offset:8960
 ds_read_b128 v[168:171], v14 offset:26112
 ds_read_b128 v[172:175], v14 offset:26368
 s_waitcnt lgkmcnt(0)
 v_pk_add_f32 v[144:145], v[144:145], v[152:153]
 v_pk_add_f32 v[146:147], v[146:147], v[154:155]
 v_pk_add_f32 v[148:149], v[148:149], v[156:157]
 v_pk_add_f32 v[150:151], v[150:151], v[158:159]
 v_pk_add_f32 v[160:161], v[160:161], v[168:169]
 v_pk_add_f32 v[162:163], v[162:163], v[170:171]
 v_pk_add_f32 v[164:165], v[164:165], v[172:173]
 v_pk_add_f32 v[166:167], v[166:167], v[174:175]
 v_pk_add_f32 v[144:145], v[144:145], v[56:57]
 v_pk_add_f32 v[146:147], v[146:147], v[58:59]
 v_pk_add_f32 v[148:149], v[148:149], v[60:61]
 v_pk_add_f32 v[150:151], v[150:151], v[62:63]
 v_pk_add_f32 v[144:145], v[144:145], v[160:161]
 v_pk_add_f32 v[146:147], v[146:147], v[162:163]
 v_pk_add_f32 v[148:149], v[148:149], v[164:165]
 v_pk_add_f32 v[150:151], v[150:151], v[166:167]
 v_cvt_pk_bf16_f32 v160, v144, v145
 v_cvt_pk_bf16_f32 v161, v146, v147
 v_cvt_pk_bf16_f32 v162, v148, v149
 v_cvt_pk_bf16_f32 v163, v150, v151
 buffer_store_dwordx4 v[160:163], v9, s[44:47], s69 offen
L_end:
 s_endpgm
L_idle:
 s_waitcnt vmcnt(0)
 s_mul_i32 s3, s72, 250880
 s_add_u32 s3, s3, 13893632
 s_lshr_b32 s66, s80, 16
 s_mul_i32 s66, s66, 4480
 s_add_u32 s16, s66, s3
 s_add_u32 s23, s16, 125440
 s_lshr_b32 s66, s81, 16
 s_mul_i32 s66, s66, 4480
 s_add_u32 s17, s66, s3
 s_add_u32 s24, s17, 125440
 s_lshr_b32 s66, s82, 16
 s_mul_i32 s66, s66, 4480
 s_add_u32 s18, s66, s3
 s_add_u32 s25, s18, 125440
 s_lshr_b32 s66, s83, 16
 s_mul_i32 s66, s66, 4480
 s_add_u32 s19, s66, s3
 s_add_u32 s26, s19, 125440
 s_lshr_b32 s66, s84, 16
 s_mul_i32 s66, s66, 4480
 s_add_u32 s20, s66, s3
 s_add_u32 s27, s20, 125440
 s_lshr_b32 s66, s85, 16
 s_mul_i32 s66, s66, 4480
 s_add_u32 s21, s66, s3
 s_add_u32 s28, s21, 125440
 s_lshr_b32 s66, s86, 16
 s_mul_i32 s66, s66, 4480
 s_add_u32 s22, s66, s3
 s_add_u32 s29, s22, 125440
 s_lshl_b32 s68, s72, 16
 s_add_u32 s68, s68, s74
 s_add_u32 s69, s68, 32768
 s_add_u32 s76, s68, 11796480
 s_add_u32 s77, s69, 11796480
 s_lshl_b32 s3, s59, 2
 s_add_u32 s3, s3, s56
 s_mul_i32 s70, s3, 56
 s_add_u32 s70, s70, s60
 s_mul_i32 s70, s70, 4480
 s_add_u32 s70, s70, 13893632
 s_add_u32 s71, s70, 125440
 s_lshl_b32 s58, s72, 3
 s_add_u32 s58, s58, s56
 s_mul_i32 s95, s58, 31360
 s_add_u32 s95, s95, 13897984
 s_add_u32 s78, s95, 125440
 s_lshl_b32 s58, s58, 2
 s_lshr_b32 s3, s74, 8
 s_add_u32 s58, s58, s3
 s_lshl_b32 s58, s58, 7
 s_add_u32 s58, s58, 786432
 s_lshl_b32 s54, s56, 15
 s_mov_b32 s46, 2097152
 s_mov_b32 s47, 0x20000
 s_add_u32 m0, s55, 0
 s_nop 0
 buffer_load_dwordx4 v254, s[40:43], s81 offen lds
 s_add_u32 m0, s55, 1024
 s_add_u32 s100, s81, 8192
 buffer_load_dwordx4 v254, s[40:43], s100 offen lds
 s_add_u32 m0, s55, 2048
 s_add_u32 s100, s81, 16384
 buffer_load_dwordx4 v254, s[40:43], s100 offen lds
 s_add_u32 m0, s55, 3072
 s_add_u32 s100, s81, 24576
 buffer_load_dwordx4 v254, s[40:43], s100 offen lds
 s_waitcnt vmcnt(2)
 ds_read_b64_tr_b16 a[32:33], v8 offset:0
 ds_read_b64_tr_b16 a[36:37], v255 offset:0
 ds_read_b64_tr_b16 a[40:41], v253 offset:0
 ds_read_b64_tr_b16 a[44:45], v251 offset:0
 s_add_u32 m0, s55, 4096
 s_add_u32 s100, s81, 32768
 buffer_load_dwordx4 v254, s[40:43], s100 offen lds
 s_add_u32 m0, s55, 5120
 s_add_u32 s100, s81, 40960
 buffer_load_dwordx4 v254, s[40:43], s100 offen lds
 s_waitcnt vmcnt(2)
 ds_read_b64_tr_b16 a[34:35], v8 offset:2048
 ds_read_b64_tr_b16 a[38:39], v255 offset:2048
 ds_read_b64_tr_b16 a[42:43], v253 offset:2048
 ds_read_b64_tr_b16 a[46:47], v251 offset:2048
 s_add_u32 m0, s55, 6144
 s_add_u32 s100, s81, 49152
 buffer_load_dwordx4 v254, s[40:43], s100 offen lds
 s_add_u32 m0, s55, 7168
 s_add_u32 s100, s81, 57344
 buffer_load_dwordx4 v254, s[40:43], s100 offen lds
 s_waitcnt vmcnt(2)
 ds_read_b64_tr_b16 a[48:49], v8 offset:4096
 ds_read_b64_tr_b16 a[52:53], v255 offset:4096
 ds_read_b64_tr_b16 a[56:57], v253 offset:4096
 ds_read_b64_tr_b16 a[60:61], v251 offset:4096
 s_waitcnt lgkmcnt(8)
 s_add_u32 m0, s55, 0
 s_nop 0
 buffer_load_dwordx4 v254, s[40:43], s82 offen lds
 s_add_u32 m0, s55, 1024
 s_add_u32 s100, s82, 8192
 buffer_load_dwordx4 v254, s[40:43], s100 offen lds
 s_waitcnt vmcnt(2)
 ds_read_b64_tr_b16 a[50:51], v8 offset:6144
 ds_read_b64_tr_b16 a[54:55], v255 offset:6144
 ds_read_b64_tr_b16 a[58:59], v253 offset:6144
 ds_read_b64_tr_b16 a[62:63], v251 offset:6144
 s_waitcnt lgkmcnt(8)
 s_add_u32 m0, s55, 2048
 s_add_u32 s100, s82, 16384
 buffer_load_dwordx4 v254, s[40:43], s100 offen lds
 s_add_u32 m0, s55, 3072
 s_add_u32 s100, s82, 24576
 buffer_load_dwordx4 v254, s[40:43], s100 offen lds
 s_waitcnt vmcnt(2)
 ds_read_b64_tr_b16 a[64:65], v8 offset:0
 ds_read_b64_tr_b16 a[68:69], v255 offset:0
 ds_read_b64_tr_b16 a[72:73], v253 offset:0
 ds_read_b64_tr_b16 a[76:77], v251 offset:0
 s_waitcnt lgkmcnt(8)
 s_add_u32 m0, s55, 4096
 s_add_u32 s100, s82, 32768
 buffer_load_dwordx4 v254, s[40:43], s100 offen lds
 s_add_u32 m0, s55, 5120
 s_add_u32 s100, s82, 40960
 buffer_load_dwordx4 v254, s[40:43], s100 offen lds
 s_waitcnt vmcnt(2)
 ds_read_b64_tr_b16 a[66:67], v8 offset:2048
 ds_read_b64_tr_b16 a[70:71], v255 offset:2048
 ds_read_b64_tr_b16 a[74:75], v253 offset:2048
 ds_read_b64_tr_b16 a[78:79], v251 offset:2048
 s_waitcnt lgkmcnt(8)
 s_add_u32 m0, s55, 6144
 s_add_u32 s100, s82, 49152
 buffer_load_dwordx4 v254, s[40:43], s100 offen lds
 s_add_u32 m0, s55, 7168
 s_add_u32 s100, s82, 57344
 buffer_load_dwordx4 v254, s[40:43], s100 offen lds
 s_waitcnt vmcnt(2)
 ds_read_b64_tr_b16 a[80:81], v8 offset:4096
 ds_read_b64_tr_b16 a[84:85], v255 offset:4096
 ds_read_b64_tr_b16 a[88:89], v253 offset:4096
 ds_read_b64_tr_b16 a[92:93], v251 offset:4096
 s_waitcnt lgkmcnt(8)
 s_add_u32 m0, s55, 0
 s_nop 0
 buffer_load_dwordx4 v254, s[40:43], s83 offen lds
 s_add_u32 m0, s55, 1024
 s_add_u32 s100, s83, 8192
 buffer_load_dwordx4 v254, s[40:43], s100 offen lds
 s_waitcnt vmcnt(2)
 ds_read_b64_tr_b16 a[82:83], v8 offset:6144
 ds_read_b64_tr_b16 a[86:87], v255 offset:6144
 ds_read_b64_tr_b16 a[90:91], v253 offset:6144
 ds_read_b64_tr_b16 a[94:95], v251 offset:6144
 s_waitcnt lgkmcnt(8)
 s_add_u32 m0, s55, 2048
 s_add_u32 s100, s83, 16384
 buffer_load_dwordx4 v254, s[40:43], s100 offen lds
 s_add_u32 m0, s55, 3072
 s_add_u32 s100, s83, 24576
 buffer_load_dwordx4 v254, s[40:43], s100 offen lds
 s_waitcnt vmcnt(2)
 ds_read_b64_tr_b16 a[96:97], v8 offset:0
 ds_read_b64_tr_b16 a[100:101], v255 offset:0
 ds_read_b64_tr_b16 a[104:105], v253 offset:0
 ds_read_b64_tr_b16 a[108:109], v251 offset:0
 s_waitcnt lgkmcnt(8)
 s_add_u32 m0, s55, 4096
 s_add_u32 s100, s83, 32768
 buffer_load_dwordx4 v254, s[40:43], s100 offen lds
 s_add_u32 m0, s55, 5120
 s_add_u32 s100, s83, 40960
 buffer_load_dwordx4 v254, s[40:43], s100 offen lds
 s_waitcnt vmcnt(2)
 ds_read_b64_tr_b16 a[98:99], v8 offset:2048
 ds_read_b64_tr_b16 a[102:103], v255 offset:2048
 ds_read_b64_tr_b16 a[106:107], v253 offset:2048
 ds_read_b64_tr_b16 a[110:111], v251 offset:2048
 s_waitcnt lgkmcnt(8)
 s_add_u32 m0, s55, 6144
 s_add_u32 s100, s83, 49152
 buffer_load_dwordx4 v254, s[40:43], s100 offen lds
 s_add_u32 m0, s55, 7168
 s_add_u32 s100, s83, 57344
 buffer_load_dwordx4 v254, s[40:43], s100 offen lds
 s_waitcnt vmcnt(2)
 ds_read_b64_tr_b16 a[112:113], v8 offset:4096
 ds_read_b64_tr_b16 a[116:117], v255 offset:4096
 ds_read_b64_tr_b16 a[120:121], v253 offset:4096
 ds_read_b64_tr_b16 a[124:125], v251 offset:4096
 s_waitcnt lgkmcnt(8)
 s_add_u32 m0, s55, 0
 s_nop 0
 buffer_load_dwordx4 v254, s[40:43], s84 offen lds
 s_add_u32 m0, s55, 1024
 s_add_u32 s100, s84, 8192
 buffer_load_dwordx4 v254, s[40:43], s100 offen lds
 s_waitcnt vmcnt(2)
 ds_read_b64_tr_b16 a[114:115], v8 offset:6144
 ds_read_b64_tr_b16 a[118:119], v255 offset:6144
 ds_read_b64_tr_b16 a[122:123], v253 offset:6144
 ds_read_b64_tr_b16 a[126:127], v251 offset:6144
 s_waitcnt lgkmcnt(8)
 s_add_u32 m0, s55, 2048
 s_add_u32 s100, s84, 16384
 buffer_load_dwordx4 v254, s[40:43], s100 offen lds
 s_add_u32 m0, s55, 3072
 s_add_u32 s100, s84, 24576
 buffer_load_dwordx4 v254, s[40:43], s100 offen lds
 s_waitcnt vmcnt(2)
 ds_read_b64_tr_b16 a[128:129], v8 offset:0
 ds_read_b64_tr_b16 a[132:133], v255 offset:0
 ds_read_b64_tr_b16 a[136:137], v253 offset:0
 ds_read_b64_tr_b16 a[140:141], v251 offset:0
 s_waitcnt lgkmcnt(8)
 s_add_u32 m0, s55, 4096
 s_add_u32 s100, s84, 32768
 buffer_load_dwordx4 v254, s[40:43], s100 offen lds
 s_add_u32 m0, s55, 5120
 s_add_u32 s100, s84, 40960
 buffer_load_dwordx4 v254, s[40:43], s100 offen lds
 s_waitcnt vmcnt(2)
 ds_read_b64_tr_b16 a[130:131], v8 offset:2048
 ds_read_b64_tr_b16 a[134:135], v255 offset:2048
 ds_read_b64_tr_b16 a[138:139], v253 offset:2048
 ds_read_b64_tr_b16 a[142:143], v251 offset:2048
 s_waitcnt lgkmcnt(8)
 s_add_u32 m0, s55, 6144
 s_add_u32 s100, s84, 49152
 buffer_load_dwordx4 v254, s[40:43], s100 offen lds
 s_add_u32 m0, s55, 7168
 s_add_u32 s100, s84, 57344
 buffer_load_dwordx4 v254, s[40:43], s100 offen lds
 s_waitcnt vmcnt(2)
 ds_read_b64_tr_b16 a[144:145], v8 offset:4096
 ds_read_b64_tr_b16 a[148:149], v255 offset:4096
 ds_read_b64_tr_b16 a[152:153], v253 offset:4096
 ds_read_b64_tr_b16 a[156:157], v251 offset:4096
 s_waitcnt vmcnt(0)
 ds_read_b64_tr_b16 a[146:147], v8 offset:6144
 ds_read_b64_tr_b16 a[150:151], v255 offset:6144
 ds_read_b64_tr_b16 a[154:155], v253 offset:6144
 ds_read_b64_tr_b16 a[158:159], v251 offset:6144
L_ip0:
 v_mov_b32 v5, 0
 buffer_atomic_or v5, v220, s[48:51], s95 offen sc0 sc1
 s_waitcnt vmcnt(0)
 v_cmp_ne_u32 vcc, s61, v5
 s_nop 0
 s_and_b64 vcc, vcc, 127
 s_cbranch_vccz L_ip0b
 s_sleep 8
 s_sub_u32 s75, s75, 1
 s_cbranch_scc0 L_ip0
 s_mov_b32 s75, 0
L_ip0b:
 buffer_load_dwordx4 v[224:227], v6, s[48:51], s16 offen offset:0 sc1
 buffer_load_dwordx4 v[228:231], v6, s[48:51], s16 offen offset:1024 sc1
 buffer_load_dwordx4 v[232:235], v6, s[48:51], s16 offen offset:2048 sc1
 buffer_load_dwordx4 v[236:239], v6, s[48:51], s16 offen offset:3072 sc1
 buffer_load_dword v212, v2, s[48:51], s16 offen sc1
 buffer_load_dwordx4 v[80:83], v6, s[48:51], s17 offen offset:0 sc1
 buffer_load_dwordx4 v[84:87], v6, s[48:51], s17 offen offset:1024 sc1
 buffer_load_dwordx4 v[88:91], v6, s[48:51], s17 offen offset:2048 sc1
 buffer_load_dwordx4 v[92:95], v6, s[48:51], s17 offen offset:3072 sc1
 buffer_load_dword v213, v2, s[48:51], s17 offen sc1
 buffer_load_dwordx4 v[96:99], v6, s[48:51], s18 offen offset:0 sc1
 buffer_load_dwordx4 v[100:103], v6, s[48:51], s18 offen offset:1024 sc1
 buffer_load_dwordx4 v[104:107], v6, s[48:51], s18 offen offset:2048 sc1
 buffer_load_dwordx4 v[108:111], v6, s[48:51], s18 offen offset:3072 sc1
 buffer_load_dword v214, v2, s[48:51], s18 offen sc1
 buffer_load_dwordx4 v[112:115], v6, s[48:51], s19 offen offset:0 sc1
 buffer_load_dwordx4 v[116:119], v6, s[48:51], s19 offen offset:1024 sc1
 buffer_load_dwordx4 v[120:123], v6, s[48:51], s19 offen offset:2048 sc1
 buffer_load_dwordx4 v[124:127], v6, s[48:51], s19 offen offset:3072 sc1
 buffer_load_dword v215, v2, s[48:51], s19 offen sc1
 buffer_load_dwordx4 v[128:131], v6, s[48:51], s20 offen offset:0 sc1
 buffer_load_dwordx4 v[132:135], v6, s[48:51], s20 offen offset:1024 sc1
 buffer_load_dwordx4 v[136:139], v6, s[48:51], s20 offen offset:2048 sc1
 buffer_load_dwordx4 v[140:143], v6, s[48:51], s20 offen offset:3072 sc1
 buffer_load_dword v216, v2, s[48:51], s20 offen sc1
 v_lshrrev_b32 v1, 5, v6
 v_lshlrev_b32 v1, 25, v1
 v_lshl_add_u32 v1, v6, 7, v1
 buffer_load_dword v3, v1, s[48:51], s58 offen sc1
 s_waitcnt vmcnt(0) lgkmcnt(0)
 s_branch L_join
L_h1_r:
 s_mov_b64 exec, vcc
 s_sleep 4
 buffer_load_dwordx4 v[160:163], v14, s[48:51], s4 offen sc1
 buffer_load_dwordx4 v[164:167], v14, s[48:51], s5 offen sc1
 buffer_load_dwordx4 v[168:171], v14, s[48:51], s6 offen sc1
 buffer_load_dwordx4 v[172:175], v14, s[48:51], s7 offen sc1
 s_waitcnt vmcnt(0) lgkmcnt(0)
 s_sub_u32 s75, s75, 1
 s_cbranch_scc0 L_h1
 s_mov_b32 s75, 0
 s_mov_b64 exec, -1
 s_branch L_h1_ok
L_h2_r:
 s_mov_b64 exec, vcc
 s_sleep 4
 buffer_load_dwordx4 v[64:67], v14, s[48:51], s4 offen sc1
 buffer_load_dwordx4 v[68:71], v14, s[48:51], s5 offen sc1
 buffer_load_dwordx4 v[72:75], v14, s[48:51], s6 offen sc1
 buffer_load_dwordx4 v[76:79], v14, s[48:51], s7 offen sc1
 s_waitcnt vmcnt(0) lgkmcnt(0)
 s_sub_u32 s75, s75, 1
 s_cbranch_scc0 L_h2
 s_mov_b32 s75, 0
 s_mov_b64 exec, -1
 s_branch L_h2_ok
L_sia_i:
 s_waitcnt vmcnt(0)
 s_branch L_sia
L_hn0_s:
 s_sleep 4
L_hn0_r:
 s_sub_u32 s75, s75, 1
 s_cbranch_scc1 L_hn0_x
 buffer_load_dwordx4 v[16:19], v221, s[48:51], s8 offen offset:0 sc1
 buffer_load_dwordx4 v[20:23], v221, s[48:51], s8 offen offset:256 sc1
 buffer_load_dwordx4 v[24:27], v221, s[48:51], s8 offen offset:2048 sc1
 buffer_load_dwordx4 v[28:31], v221, s[48:51], s8 offen offset:2304 sc1
 buffer_load_dword v208, v248, s[48:51], s87 offen sc1
 buffer_load_dwordx4 v[32:35], v221, s[48:51], s9 offen offset:0 sc1
 buffer_load_dwordx4 v[36:39], v221, s[48:51], s9 offen offset:256 sc1
 buffer_load_dwordx4 v[40:43], v221, s[48:51], s9 offen offset:2048 sc1
 buffer_load_dwordx4 v[44:47], v221, s[48:51], s9 offen offset:2304 sc1
 buffer_load_dword v209, v248, s[48:51], s88 offen sc1
 buffer_load_dwordx4 v[48:51], v221, s[48:51], s10 offen offset:0 sc1
 buffer_load_dwordx4 v[52:55], v221, s[48:51], s10 offen offset:256 sc1
 buffer_load_dwordx4 v[56:59], v221, s[48:51], s10 offen offset:2048 sc1
 buffer_load_dwordx4 v[60:63], v221, s[48:51], s10 offen offset:2304 sc1
 buffer_load_dword v210, v248, s[48:51], s89 offen sc1
 s_waitcnt vmcnt(10)
 v_xad_u32 v4, v16, v17, s61
 v_add3_u32 v4, v4, v18, v19
 v_xad_u32 v4, v20, v21, v4
 v_add3_u32 v4, v4, v22, v23
 v_xad_u32 v4, v24, v25, v4
 v_add3_u32 v4, v4, v26, v27
 v_xad_u32 v4, v28, v29, v4
 v_add3_u32 v4, v4, v30, v31
 v_cmp_ne_u32 vcc, v4, v208
 s_cbranch_vccnz L_hn0_s
 s_branch L_hn0_b
L_hn0_x:
 s_mov_b32 s75, 0
 s_branch L_hn0_b
L_hn1_s:
 s_sleep 4
L_hn1_r:
 s_sub_u32 s75, s75, 1
 s_cbranch_scc1 L_hn1_x
 buffer_load_dwordx4 v[32:35], v221, s[48:51], s9 offen offset:0 sc1
 buffer_load_dwordx4 v[36:39], v221, s[48:51], s9 offen offset:256 sc1
 buffer_load_dwordx4 v[40:43], v221, s[48:51], s9 offen offset:2048 sc1
 buffer_load_dwordx4 v[44:47], v221, s[48:51], s9 offen offset:2304 sc1
 buffer_load_dword v209, v248, s[48:51], s88 offen sc1
 buffer_load_dwordx4 v[48:51], v221, s[48:51], s10 offen offset:0 sc1
 buffer_load_dwordx4 v[52:55], v221, s[48:51], s10 offen offset:256 sc1
 buffer_load_dwordx4 v[56:59], v221, s[48:51], s10 offen offset:2048 sc1
 buffer_load_dwordx4 v[60:63], v221, s[48:51], s10 offen offset:2304 sc1
 buffer_load_dword v210, v248, s[48:51], s89 offen sc1
 buffer_load_dwordx4 v[64:67], v221, s[48:51], s11 offen offset:0 sc1
 buffer_load_dwordx4 v[68:71], v221, s[48:51], s11 offen offset:256 sc1
 buffer_load_dwordx4 v[72:75], v221, s[48:51], s11 offen offset:2048 sc1
 buffer_load_dwordx4 v[76:79], v221, s[48:51], s11 offen offset:2304 sc1
 buffer_load_dword v211, v248, s[48:51], s90 offen sc1
 s_waitcnt vmcnt(10)
 v_xad_u32 v4, v32, v33, s61
 v_add3_u32 v4, v4, v34, v35
 v_xad_u32 v4, v36, v37, v4
 v_add3_u32 v4, v4, v38, v39
 v_xad_u32 v4, v40, v41, v4
 v_add3_u32 v4, v4, v42, v43
 v_xad_u32 v4, v44, v45, v4
 v_add3_u32 v4, v4, v46, v47
 v_cmp_ne_u32 vcc, v4, v209
 s_cbranch_vccnz L_hn1_s
 s_branch L_hn1_b
L_hn1_x:
 s_mov_b32 s75, 0
 s_branch L_hn1_b
L_hn2_s:
 s_sleep 4
L_hn2_r:
 s_sub_u32 s75, s75, 1
 s_cbranch_scc1 L_hn2_x
 buffer_load_dwordx4 v[48:51], v221, s[48:51], s10 offen offset:0 sc1
 buffer_load_dwordx4 v[52:55], v221, s[48:51], s10 offen offset:256 sc1
 buffer_load_dwordx4 v[56:59], v221, s[48:51], s10 offen offset:2048 sc1
 buffer_load_dwordx4 v[60:63], v221, s[48:51], s10 offen offset:2304 sc1
 buffer_load_dword v210, v248, s[48:51], s89 offen sc1
 buffer_load_dwordx4 v[64:67], v221, s[48:51], s11 offen offset:0 sc1
 buffer_load_dwordx4 v[68:71], v221, s[48:51], s11 offen offset:256 sc1
 buffer_load_dwordx4 v[72:75], v221, s[48:51], s11 offen offset:2048 sc1
 buffer_load_dwordx4 v[76:79], v221, s[48:51], s11 offen offset:2304 sc1
 buffer_load_dword v211, v248, s[48:51], s90 offen sc1
 buffer_load_dwordx4 v[16:19], v221, s[48:51], s12 offen offset:0 sc1
 buffer_load_dwordx4 v[20:23], v221, s[48:51], s12 offen offset:256 sc1
 buffer_load_dwordx4 v[24:27], v221, s[48:51], s12 offen offset:2048 sc1
 buffer_load_dwordx4 v[28:31], v221, s[48:51], s12 offen offset:2304 sc1
 buffer_load_dword v208, v248, s[48:51], s91 offen sc1
 s_waitcnt vmcnt(10)
 v_xad_u32 v4, v48, v49, s61
 v_add3_u32 v4, v4, v50, v51
 v_xad_u32 v4, v52, v53, v4
 v_add3_u32 v4, v4, v54, v55
 v_xad_u32 v4, v56, v57, v4
 v_add3_u32 v4, v4, v58, v59
 v_xad_u32 v4, v60, v61, v4
 v_add3_u32 v4, v4, v62, v63
 v_cmp_ne_u32 vcc, v4, v210
 s_cbranch_vccnz L_hn2_s
 s_branch L_hn2_b
L_hn2_x:
 s_mov_b32 s75, 0
 s_branch L_hn2_b
L_hn3_s:
 s_sleep 4
L_hn3_r:
 s_sub_u32 s75, s75, 1
 s_cbranch_scc1 L_hn3_x
 buffer_load_dwordx4 v[64:67], v221, s[48:51], s11 offen offset:0 sc1
 buffer_load_dwordx4 v[68:71], v221, s[48:51], s11 offen offset:256 sc1
 buffer_load_dwordx4 v[72:75], v221, s[48:51], s11 offen offset:2048 sc1
 buffer_load_dwordx4 v[76:79], v221, s[48:51], s11 offen offset:2304 sc1
 buffer_load_dword v211, v248, s[48:51], s90 offen sc1
 buffer_load_dwordx4 v[16:19], v221, s[48:51], s12 offen offset:0 sc1
 buffer_load_dwordx4 v[20:23], v221, s[48:51], s12 offen offset:256 sc1
 buffer_load_dwordx4 v[24:27], v221, s[48:51], s12 offen offset:2048 sc1
 buffer_load_dwordx4 v[28:31], v221, s[48:51], s12 offen offset:2304 sc1
 buffer_load_dword v208, v248, s[48:51], s91 offen sc1
 buffer_load_dwordx4 v[32:35], v221, s[48:51], s13 offen offset:0 sc1
 buffer_load_dwordx4 v[36:39], v221, s[48:51], s13 offen offset:256 sc1
 buffer_load_dwordx4 v[40:43], v221, s[48:51], s13 offen offset:2048 sc1
 buffer_load_dwordx4 v[44:47], v221, s[48:51], s13 offen offset:2304 sc1
 buffer_load_dword v209, v248, s[48:51], s92 offen sc1
 s_waitcnt vmcnt(10)
 v_xad_u32 v4, v64, v65, s61
 v_add3_u32 v4, v4, v66, v67
 v_xad_u32 v4, v68, v69, v4
 v_add3_u32 v4, v4, v70, v71
 v_xad_u32 v4, v72, v73, v4
 v_add3_u32 v4, v4, v74, v75
 v_xad_u32 v4, v76, v77, v4
 v_add3_u32 v4, v4, v78, v79
 v_cmp_ne_u32 vcc, v4, v211
 s_cbranch_vccnz L_hn3_s
 s_branch L_hn3_b
L_hn3_x:
 s_mov_b32 s75, 0
 s_branch L_hn3_b
L_hn4_s:
 s_sleep 4
L_hn4_r:
 s_sub_u32 s75, s75, 1
 s_cbranch_scc1 L_hn4_x
 buffer_load_dwordx4 v[16:19], v221, s[48:51], s12 offen offset:0 sc1
 buffer_load_dwordx4 v[20:23], v221, s[48:51], s12 offen offset:256 sc1
 buffer_load_dwordx4 v[24:27], v221, s[48:51], s12 offen offset:2048 sc1
 buffer_load_dwordx4 v[28:31], v221, s[48:51], s12 offen offset:2304 sc1
 buffer_load_dword v208, v248, s[48:51], s91 offen sc1
 buffer_load_dwordx4 v[32:35], v221, s[48:51], s13 offen offset:0 sc1
 buffer_load_dwordx4 v[36:39], v221, s[48:51], s13 offen offset:256 sc1
 buffer_load_dwordx4 v[40:43], v221, s[48:51], s13 offen offset:2048 sc1
 buffer_load_dwordx4 v[44:47], v221, s[48:51], s13 offen offset:2304 sc1
 buffer_load_dword v209, v248, s[48:51], s92 offen sc1
 buffer_load_dwordx4 v[48:51], v221, s[48:51], s14 offen offset:0 sc1
 buffer_load_dwordx4 v[52:55], v221, s[48:51], s14 offen offset:256 sc1
 buffer_load_dwordx4 v[56:59], v221, s[48:51], s14 offen offset:2048 sc1
 buffer_load_dwordx4 v[60:63], v221, s[48:51], s14 offen offset:2304 sc1
 buffer_load_dword v210, v248, s[48:51], s93 offen sc1
 s_waitcnt vmcnt(10)
 v_xad_u32 v4, v16, v17, s61
 v_add3_u32 v4, v4, v18, v19
 v_xad_u32 v4, v20, v21, v4
 v_add3_u32 v4, v4, v22, v23
 v_xad_u32 v4, v24, v25, v4
 v_add3_u32 v4, v4, v26, v27
 v_xad_u32 v4, v28, v29, v4
 v_add3_u32 v4, v4, v30, v31
 v_cmp_ne_u32 vcc, v4, v208
 s_cbranch_vccnz L_hn4_s
 s_branch L_hn4_b
L_hn4_x:
 s_mov_b32 s75, 0
 s_branch L_hn4_b
L_fp_r:
 s_sub_u32 s75, s75, 1
 s_cbranch_scc1 L_fp_x
 s_sleep 4
 buffer_load_dword v5, v249, s[48:51], s97 offen sc1
 s_waitcnt vmcnt(0)
 v_cmp_ne_u32 vcc, s61, v5
 s_cbranch_vccnz L_fp_r
 s_branch L_fp_b
L_fp_x:
 s_mov_b32 s75, 0
 s_branch L_fp_b
L_hn5_s:
 s_sleep 4
L_hn5_r:
 s_sub_u32 s75, s75, 1
 s_cbranch_scc1 L_hn5_x
 buffer_load_dwordx4 v[32:35], v221, s[48:51], s13 offen offset:0 sc1
 buffer_load_dwordx4 v[36:39], v221, s[48:51], s13 offen offset:256 sc1
 buffer_load_dwordx4 v[40:43], v221, s[48:51], s13 offen offset:2048 sc1
 buffer_load_dwordx4 v[44:47], v221, s[48:51], s13 offen offset:2304 sc1
 buffer_load_dword v209, v248, s[48:51], s92 offen sc1
 buffer_load_dwordx4 v[48:51], v221, s[48:51], s14 offen offset:0 sc1
 buffer_load_dwordx4 v[52:55], v221, s[48:51], s14 offen offset:256 sc1
 buffer_load_dwordx4 v[56:59], v221, s[48:51], s14 offen offset:2048 sc1
 buffer_load_dwordx4 v[60:63], v221, s[48:51], s14 offen offset:2304 sc1
 buffer_load_dword v210, v248, s[48:51], s93 offen sc1
 s_waitcnt vmcnt(5)
 v_xad_u32 v4, v32, v33, s61
 v_add3_u32 v4, v4, v34, v35
 v_xad_u32 v4, v36, v37, v4
 v_add3_u32 v4, v4, v38, v39
 v_xad_u32 v4, v40, v41, v4
 v_add3_u32 v4, v4, v42, v43
 v_xad_u32 v4, v44, v45, v4
 v_add3_u32 v4, v4, v46, v47
 v_cmp_ne_u32 vcc, v4, v209
 s_cbranch_vccnz L_hn5_s
 s_branch L_hn5_b
L_hn5_x:
 s_mov_b32 s75, 0
 s_branch L_hn5_b
L_hn6_s:
 s_sleep 4
L_hn6_r:
 s_sub_u32 s75, s75, 1
 s_cbranch_scc1 L_hn6_x
 buffer_load_dwordx4 v[48:51], v221, s[48:51], s14 offen offset:0 sc1
 buffer_load_dwordx4 v[52:55], v221, s[48:51], s14 offen offset:256 sc1
 buffer_load_dwordx4 v[56:59], v221, s[48:51], s14 offen offset:2048 sc1
 buffer_load_dwordx4 v[60:63], v221, s[48:51], s14 offen offset:2304 sc1
 buffer_load_dword v210, v248, s[48:51], s93 offen sc1
 s_waitcnt vmcnt(0)
 v_xad_u32 v4, v48, v49, s61
 v_add3_u32 v4, v4, v50, v51
 v_xad_u32 v4, v52, v53, v4
 v_add3_u32 v4, v4, v54, v55
 v_xad_u32 v4, v56, v57, v4
 v_add3_u32 v4, v4, v58, v59
 v_xad_u32 v4, v60, v61, v4
 v_add3_u32 v4, v4, v62, v63
 v_cmp_ne_u32 vcc, v4, v210
 s_cbranch_vccnz L_hn6_s
 s_branch L_hn6_b
L_hn6_x:
 s_mov_b32 s75, 0
 s_branch L_hn6_b
L_ip1:
 v_mov_b32 v5, 0
 buffer_atomic_or v5, v220, s[48:51], s78 offen sc0 sc1
 s_waitcnt vmcnt(0)
 v_cmp_ne_u32 vcc, s61, v5
 s_nop 0
 s_and_b64 vcc, vcc, 127
 s_cbranch_vccz L_ip1b
 s_sleep 8
 s_sub_u32 s75, s75, 1
 s_cbranch_scc0 L_ip1
 s_mov_b32 s75, 0
 s_branch L_ip1b
L_flag_r:
 s_sub_u32 s75, s75, 1
 s_cbranch_scc1 L_flag_x
 s_sleep 4
 buffer_load_dword v3, v1, s[48:51], s58 offen sc1
 s_waitcnt vmcnt(0)
 v_cmp_ne_u32 vcc, s61, v3
 s_nop 0
 s_and_b64 vcc, vcc, 3
 s_cbranch_vccnz L_flag_r
 s_branch L_flag_b
L_flag_x:
 s_mov_b32 s75, 0
 s_branch L_flag_b
L_hh0_0_r:
 s_sub_u32 s75, s75, 1
 s_cbranch_scc1 L_hh0_0_x
 s_sleep 4
 buffer_load_dwordx4 v[224:227], v6, s[48:51], s16 offen offset:0 sc1
 buffer_load_dwordx4 v[228:231], v6, s[48:51], s16 offen offset:1024 sc1
 buffer_load_dwordx4 v[232:235], v6, s[48:51], s16 offen offset:2048 sc1
 buffer_load_dwordx4 v[236:239], v6, s[48:51], s16 offen offset:3072 sc1
 buffer_load_dword v212, v2, s[48:51], s16 offen sc1
 s_waitcnt vmcnt(0)
 v_xad_u32 v4, v224, v225, s61
 v_add3_u32 v4, v4, v226, v227
 v_xad_u32 v4, v228, v229, v4
 v_add3_u32 v4, v4, v230, v231
 v_xad_u32 v4, v232, v233, v4
 v_add3_u32 v4, v4, v234, v235
 v_xad_u32 v4, v236, v237, v4
 v_add3_u32 v4, v4, v238, v239
 v_cmp_ne_u32 vcc, v4, v212
 s_cbranch_vccnz L_hh0_0_r
 buffer_load_dwordx4 v[80:83], v6, s[48:51], s17 offen offset:0 sc1
 buffer_load_dwordx4 v[84:87], v6, s[48:51], s17 offen offset:1024 sc1
 buffer_load_dwordx4 v[88:91], v6, s[48:51], s17 offen offset:2048 sc1
 buffer_load_dwordx4 v[92:95], v6, s[48:51], s17 offen offset:3072 sc1
 buffer_load_dword v213, v2, s[48:51], s17 offen sc1
 buffer_load_dwordx4 v[96:99], v6, s[48:51], s18 offen offset:0 sc1
 buffer_load_dwordx4 v[100:103], v6, s[48:51], s18 offen offset:1024 sc1
 buffer_load_dwordx4 v[104:107], v6, s[48:51], s18 offen offset:2048 sc1
 buffer_load_dwordx4 v[108:111], v6, s[48:51], s18 offen offset:3072 sc1
 buffer_load_dword v214, v2, s[48:51], s18 offen sc1
 buffer_load_dwordx4 v[112:115], v6, s[48:51], s19 offen offset:0 sc1
 buffer_load_dwordx4 v[116:119], v6, s[48:51], s19 offen offset:1024 sc1
 buffer_load_dwordx4 v[120:123], v6, s[48:51], s19 offen offset:2048 sc1
 buffer_load_dwordx4 v[124:127], v6, s[48:51], s19 offen offset:3072 sc1
 buffer_load_dword v215, v2, s[48:51], s19 offen sc1
 buffer_load_dwordx4 v[128:131], v6, s[48:51], s20 offen offset:0 sc1
 buffer_load_dwordx4 v[132:135], v6, s[48:51], s20 offen offset:1024 sc1
 buffer_load_dwordx4 v[136:139], v6, s[48:51], s20 offen offset:2048 sc1
 buffer_load_dwordx4 v[140:143], v6, s[48:51], s20 offen offset:3072 sc1
 buffer_load_dword v216, v2, s[48:51], s20 offen sc1
 s_waitcnt vmcnt(0)
 s_branch L_hh0_0_b
L_hh0_0_x:
 s_mov_b32 s75, 0
 s_branch L_hh0_0_b
L_hh0_1_r:
 s_sub_u32 s75, s75, 1
 s_cbranch_scc1 L_hh0_1_x
 s_sleep 4
 buffer_load_dwordx4 v[80:83], v6, s[48:51], s17 offen offset:0 sc1
 buffer_load_dwordx4 v[84:87], v6, s[48:51], s17 offen offset:1024 sc1
 buffer_load_dwordx4 v[88:91], v6, s[48:51], s17 offen offset:2048 sc1
 buffer_load_dwordx4 v[92:95], v6, s[48:51], s17 offen offset:3072 sc1
 buffer_load_dword v213, v2, s[48:51], s17 offen sc1
 s_waitcnt vmcnt(0)
 v_xad_u32 v4, v80, v81, s61
 v_add3_u32 v4, v4, v82, v83
 v_xad_u32 v4, v84, v85, v4
 v_add3_u32 v4, v4, v86, v87
 v_xad_u32 v4, v88, v89, v4
 v_add3_u32 v4, v4, v90, v91
 v_xad_u32 v4, v92, v93, v4
 v_add3_u32 v4, v4, v94, v95
 v_cmp_ne_u32 vcc, v4, v213
 s_cbranch_vccnz L_hh0_1_r
 buffer_load_dwordx4 v[96:99], v6, s[48:51], s18 offen offset:0 sc1
 buffer_load_dwordx4 v[100:103], v6, s[48:51], s18 offen offset:1024 sc1
 buffer_load_dwordx4 v[104:107], v6, s[48:51], s18 offen offset:2048 sc1
 buffer_load_dwordx4 v[108:111], v6, s[48:51], s18 offen offset:3072 sc1
 buffer_load_dword v214, v2, s[48:51], s18 offen sc1
 buffer_load_dwordx4 v[112:115], v6, s[48:51], s19 offen offset:0 sc1
 buffer_load_dwordx4 v[116:119], v6, s[48:51], s19 offen offset:1024 sc1
 buffer_load_dwordx4 v[120:123], v6, s[48:51], s19 offen offset:2048 sc1
 buffer_load_dwordx4 v[124:127], v6, s[48:51], s19 offen offset:3072 sc1
 buffer_load_dword v215, v2, s[48:51], s19 offen sc1
 buffer_load_dwordx4 v[128:131], v6, s[48:51], s20 offen offset:0 sc1
 buffer_load_dwordx4 v[132:135], v6, s[48:51], s20 offen offset:1024 sc1
 buffer_load_dwordx4 v[136:139], v6, s[48:51], s20 offen offset:2048 sc1
 buffer_load_dwordx4 v[140:143], v6, s[48:51], s20 offen offset:3072 sc1
 buffer_load_dword v216, v2, s[48:51], s20 offen sc1
 s_waitcnt vmcnt(0)
 s_branch L_hh0_1_b
L_hh0_1_x:
 s_mov_b32 s75, 0
 s_branch L_hh0_1_b
L_hh0_2_r:
 s_sub_u32 s75, s75, 1
 s_cbranch_scc1 L_hh0_2_x
 s_sleep 4
 buffer_load_dwordx4 v[96:99], v6, s[48:51], s18 offen offset:0 sc1
 buffer_load_dwordx4 v[100:103], v6, s[48:51], s18 offen offset:1024 sc1
 buffer_load_dwordx4 v[104:107], v6, s[48:51], s18 offen offset:2048 sc1
 buffer_load_dwordx4 v[108:111], v6, s[48:51], s18 offen offset:3072 sc1
 buffer_load_dword v214, v2, s[48:51], s18 offen sc1
 s_waitcnt vmcnt(0)
 v_xad_u32 v4, v96, v97, s61
 v_add3_u32 v4, v4, v98, v99
 v_xad_u32 v4, v100, v101, v4
 v_add3_u32 v4, v4, v102, v103
 v_xad_u32 v4, v104, v105, v4
 v_add3_u32 v4, v4, v106, v107
 v_xad_u32 v4, v108, v109, v4
 v_add3_u32 v4, v4, v110, v111
 v_cmp_ne_u32 vcc, v4, v214
 s_cbranch_vccnz L_hh0_2_r
 buffer_load_dwordx4 v[112:115], v6, s[48:51], s19 offen offset:0 sc1
 buffer_load_dwordx4 v[116:119], v6, s[48:51], s19 offen offset:1024 sc1
 buffer_load_dwordx4 v[120:123], v6, s[48:51], s19 offen offset:2048 sc1
 buffer_load_dwordx4 v[124:127], v6, s[48:51], s19 offen offset:3072 sc1
 buffer_load_dword v215, v2, s[48:51], s19 offen sc1
 buffer_load_dwordx4 v[128:131], v6, s[48:51], s20 offen offset:0 sc1
 buffer_load_dwordx4 v[132:135], v6, s[48:51], s20 offen offset:1024 sc1
 buffer_load_dwordx4 v[136:139], v6, s[48:51], s20 offen offset:2048 sc1
 buffer_load_dwordx4 v[140:143], v6, s[48:51], s20 offen offset:3072 sc1
 buffer_load_dword v216, v2, s[48:51], s20 offen sc1
 buffer_load_dwordx4 v[16:19], v6, s[48:51], s21 offen offset:0 sc1
 buffer_load_dwordx4 v[20:23], v6, s[48:51], s21 offen offset:1024 sc1
 buffer_load_dwordx4 v[24:27], v6, s[48:51], s21 offen offset:2048 sc1
 buffer_load_dwordx4 v[28:31], v6, s[48:51], s21 offen offset:3072 sc1
 buffer_load_dword v217, v2, s[48:51], s21 offen sc1
 s_waitcnt vmcnt(0)
 s_branch L_hh0_2_b
L_hh0_2_x:
 s_mov_b32 s75, 0
 s_branch L_hh0_2_b
L_hh0_3_r:
 s_sub_u32 s75, s75, 1
 s_cbranch_scc1 L_hh0_3_x
 s_sleep 4
 buffer_load_dwordx4 v[112:115], v6, s[48:51], s19 offen offset:0 sc1
 buffer_load_dwordx4 v[116:119], v6, s[48:51], s19 offen offset:1024 sc1
 buffer_load_dwordx4 v[120:123], v6, s[48:51], s19 offen offset:2048 sc1
 buffer_load_dwordx4 v[124:127], v6, s[48:51], s19 offen offset:3072 sc1
 buffer_load_dword v215, v2, s[48:51], s19 offen sc1
 s_waitcnt vmcnt(0)
 v_xad_u32 v4, v112, v113, s61
 v_add3_u32 v4, v4, v114, v115
 v_xad_u32 v4, v116, v117, v4
 v_add3_u32 v4, v4, v118, v119
 v_xad_u32 v4, v120, v121, v4
 v_add3_u32 v4, v4, v122, v123
 v_xad_u32 v4, v124, v125, v4
 v_add3_u32 v4, v4, v126, v127
 v_cmp_ne_u32 vcc, v4, v215
 s_cbranch_vccnz L_hh0_3_r
 buffer_load_dwordx4 v[128:131], v6, s[48:51], s20 offen offset:0 sc1
 buffer_load_dwordx4 v[132:135], v6, s[48:51], s20 offen offset:1024 sc1
 buffer_load_dwordx4 v[136:139], v6, s[48:51], s20 offen offset:2048 sc1
 buffer_load_dwordx4 v[140:143], v6, s[48:51], s20 offen offset:3072 sc1
 buffer_load_dword v216, v2, s[48:51], s20 offen sc1
 buffer_load_dwordx4 v[16:19], v6, s[48:51], s21 offen offset:0 sc1
 buffer_load_dwordx4 v[20:23], v6, s[48:51], s21 offen offset:1024 sc1
 buffer_load_dwordx4 v[24:27], v6, s[48:51], s21 offen offset:2048 sc1
 buffer_load_dwordx4 v[28:31], v6, s[48:51], s21 offen offset:3072 sc1
 buffer_load_dword v217, v2, s[48:51], s21 offen sc1
 s_waitcnt vmcnt(0)
 s_branch L_hh0_3_b
L_hh0_3_x:
 s_mov_b32 s75, 0
 s_branch L_hh0_3_b
L_hh0_4_r:
 s_sub_u32 s75, s75, 1
 s_cbranch_scc1 L_hh0_4_x
 s_sleep 4
 buffer_load_dwordx4 v[128:131], v6, s[48:51], s20 offen offset:0 sc1
 buffer_load_dwordx4 v[132:135], v6, s[48:51], s20 offen offset:1024 sc1
 buffer_load_dwordx4 v[136:139], v6, s[48:51], s20 offen offset:2048 sc1
 buffer_load_dwordx4 v[140:143], v6, s[48:51], s20 offen offset:3072 sc1
 buffer_load_dword v216, v2, s[48:51], s20 offen sc1
 s_waitcnt vmcnt(0)
 v_xad_u32 v4, v128, v129, s61
 v_add3_u32 v4, v4, v130, v131
 v_xad_u32 v4, v132, v133, v4
 v_add3_u32 v4, v4, v134, v135
 v_xad_u32 v4, v136, v137, v4
 v_add3_u32 v4, v4, v138, v139
 v_xad_u32 v4, v140, v141, v4
 v_add3_u32 v4, v4, v142, v143
 v_cmp_ne_u32 vcc, v4, v216
 s_cbranch_vccnz L_hh0_4_r
 buffer_load_dwordx4 v[16:19], v6, s[48:51], s21 offen offset:0 sc1
 buffer_load_dwordx4 v[20:23], v6, s[48:51], s21 offen offset:1024 sc1
 buffer_load_dwordx4 v[24:27], v6, s[48:51], s21 offen offset:2048 sc1
 buffer_load_dwordx4 v[28:31], v6, s[48:51], s21 offen offset:3072 sc1
 buffer_load_dword v217, v2, s[48:51], s21 offen sc1
 s_waitcnt vmcnt(0)
 s_branch L_hh0_4_b
L_hh0_4_x:
 s_mov_b32 s75, 0
 s_branch L_hh0_4_b
L_hh0_5_r:
 s_sub_u32 s75, s75, 1
 s_cbranch_scc1 L_hh0_5_x
 s_sleep 4
 buffer_load_dwordx4 v[16:19], v6, s[48:51], s21 offen offset:0 sc1
 buffer_load_dwordx4 v[20:23], v6, s[48:51], s21 offen offset:1024 sc1
 buffer_load_dwordx4 v[24:27], v6, s[48:51], s21 offen offset:2048 sc1
 buffer_load_dwordx4 v[28:31], v6, s[48:51], s21 offen offset:3072 sc1
 buffer_load_dword v217, v2, s[48:51], s21 offen sc1
 s_waitcnt vmcnt(0)
 v_xad_u32 v4, v16, v17, s61
 v_add3_u32 v4, v4, v18, v19
 v_xad_u32 v4, v20, v21, v4
 v_add3_u32 v4, v4, v22, v23
 v_xad_u32 v4, v24, v25, v4
 v_add3_u32 v4, v4, v26, v27
 v_xad_u32 v4, v28, v29, v4
 v_add3_u32 v4, v4, v30, v31
 v_cmp_ne_u32 vcc, v4, v217
 s_cbranch_vccnz L_hh0_5_r
 buffer_load_dwordx4 v[32:35], v6, s[48:51], s22 offen offset:0 sc1
 buffer_load_dwordx4 v[36:39], v6, s[48:51], s22 offen offset:1024 sc1
 buffer_load_dwordx4 v[40:43], v6, s[48:51], s22 offen offset:2048 sc1
 buffer_load_dwordx4 v[44:47], v6, s[48:51], s22 offen offset:3072 sc1
 buffer_load_dword v218, v2, s[48:51], s22 offen sc1
 s_waitcnt vmcnt(0)
 s_branch L_hh0_5_b
L_hh0_5_x:
 s_mov_b32 s75, 0
 s_branch L_hh0_5_b
L_hh0_6_r:
 s_sub_u32 s75, s75, 1
 s_cbranch_scc1 L_hh0_6_x
 s_sleep 4
 buffer_load_dwordx4 v[32:35], v6, s[48:51], s22 offen offset:0 sc1
 buffer_load_dwordx4 v[36:39], v6, s[48:51], s22 offen offset:1024 sc1
 buffer_load_dwordx4 v[40:43], v6, s[48:51], s22 offen offset:2048 sc1
 buffer_load_dwordx4 v[44:47], v6, s[48:51], s22 offen offset:3072 sc1
 buffer_load_dword v218, v2, s[48:51], s22 offen sc1
 s_waitcnt vmcnt(0)
 v_xad_u32 v4, v32, v33, s61
 v_add3_u32 v4, v4, v34, v35
 v_xad_u32 v4, v36, v37, v4
 v_add3_u32 v4, v4, v38, v39
 v_xad_u32 v4, v40, v41, v4
 v_add3_u32 v4, v4, v42, v43
 v_xad_u32 v4, v44, v45, v4
 v_add3_u32 v4, v4, v46, v47
 v_cmp_ne_u32 vcc, v4, v218
 s_cbranch_vccnz L_hh0_6_r
 s_branch L_hh0_6_b
L_hh0_6_x:
 s_mov_b32 s75, 0
 s_branch L_hh0_6_b
L_hh1_0_r:
 s_sub_u32 s75, s75, 1
 s_cbranch_scc1 L_hh1_0_x
 s_sleep 4
 buffer_load_dwordx4 v[144:147], v6, s[48:51], s23 offen offset:0 sc1
 buffer_load_dwordx4 v[148:151], v6, s[48:51], s23 offen offset:1024 sc1
 buffer_load_dwordx4 v[152:155], v6, s[48:51], s23 offen offset:2048 sc1
 buffer_load_dwordx4 v[156:159], v6, s[48:51], s23 offen offset:3072 sc1
 buffer_load_dword v208, v2, s[48:51], s23 offen sc1
 s_waitcnt vmcnt(0)
 v_xad_u32 v4, v144, v145, s61
 v_add3_u32 v4, v4, v146, v147
 v_xad_u32 v4, v148, v149, v4
 v_add3_u32 v4, v4, v150, v151
 v_xad_u32 v4, v152, v153, v4
 v_add3_u32 v4, v4, v154, v155
 v_xad_u32 v4, v156, v157, v4
 v_add3_u32 v4, v4, v158, v159
 v_cmp_ne_u32 vcc, v4, v208
 s_cbranch_vccnz L_hh1_0_r
 buffer_load_dwordx4 v[160:163], v6, s[48:51], s24 offen offset:0 sc1
 buffer_load_dwordx4 v[164:167], v6, s[48:51], s24 offen offset:1024 sc1
 buffer_load_dwordx4 v[168:171], v6, s[48:51], s24 offen offset:2048 sc1
 buffer_load_dwordx4 v[172:175], v6, s[48:51], s24 offen offset:3072 sc1
 buffer_load_dword v209, v2, s[48:51], s24 offen sc1
 buffer_load_dwordx4 v[176:179], v6, s[48:51], s25 offen offset:0 sc1
 buffer_load_dwordx4 v[180:183], v6, s[48:51], s25 offen offset:1024 sc1
 buffer_load_dwordx4 v[184:187], v6, s[48:51], s25 offen offset:2048 sc1
 buffer_load_dwordx4 v[188:191], v6, s[48:51], s25 offen offset:3072 sc1
 buffer_load_dword v210, v2, s[48:51], s25 offen sc1
 s_waitcnt vmcnt(0)
 s_branch L_hh1_0_b
L_hh1_0_x:
 s_mov_b32 s75, 0
 s_branch L_hh1_0_b
L_hh1_1_r:
 s_sub_u32 s75, s75, 1
 s_cbranch_scc1 L_hh1_1_x
 s_sleep 4
 buffer_load_dwordx4 v[160:163], v6, s[48:51], s24 offen offset:0 sc1
 buffer_load_dwordx4 v[164:167], v6, s[48:51], s24 offen offset:1024 sc1
 buffer_load_dwordx4 v[168:171], v6, s[48:51], s24 offen offset:2048 sc1
 buffer_load_dwordx4 v[172:175], v6, s[48:51], s24 offen offset:3072 sc1
 buffer_load_dword v209, v2, s[48:51], s24 offen sc1
 s_waitcnt vmcnt(0)
 v_xad_u32 v4, v160, v161, s61
 v_add3_u32 v4, v4, v162, v163
 v_xad_u32 v4, v164, v165, v4
 v_add3_u32 v4, v4, v166, v167
 v_xad_u32 v4, v168, v169, v4
 v_add3_u32 v4, v4, v170, v171
 v_xad_u32 v4, v172, v173, v4
 v_add3_u32 v4, v4, v174, v175
 v_cmp_ne_u32 vcc, v4, v209
 s_cbranch_vccnz L_hh1_1_r
 buffer_load_dwordx4 v[176:179], v6, s[48:51], s25 offen offset:0 sc1
 buffer_load_dwordx4 v[180:183], v6, s[48:51], s25 offen offset:1024 sc1
 buffer_load_dwordx4 v[184:187], v6, s[48:51], s25 offen offset:2048 sc1
 buffer_load_dwordx4 v[188:191], v6, s[48:51], s25 offen offset:3072 sc1
 buffer_load_dword v210, v2, s[48:51], s25 offen sc1
 buffer_load_dwordx4 v[192:195], v6, s[48:51], s26 offen offset:0 sc1
 buffer_load_dwordx4 v[196:199], v6, s[48:51], s26 offen offset:1024 sc1
 buffer_load_dwordx4 v[200:203], v6, s[48:51], s26 offen offset:2048 sc1
 buffer_load_dwordx4 v[204:207], v6, s[48:51], s26 offen offset:3072 sc1
 buffer_load_dword v211, v2, s[48:51], s26 offen sc1
 s_waitcnt vmcnt(0)
 s_branch L_hh1_1_b
L_hh1_1_x:
 s_mov_b32 s75, 0
 s_branch L_hh1_1_b
L_hh1_2_r:
 s_sub_u32 s75, s75, 1
 s_cbranch_scc1 L_hh1_2_x
 s_sleep 4
 buffer_load_dwordx4 v[176:179], v6, s[48:51], s25 offen offset:0 sc1
 buffer_load_dwordx4 v[180:183], v6, s[48:51], s25 offen offset:1024 sc1
 buffer_load_dwordx4 v[184:187], v6, s[48:51], s25 offen offset:2048 sc1
 buffer_load_dwordx4 v[188:191], v6, s[48:51], s25 offen offset:3072 sc1
 buffer_load_dword v210, v2, s[48:51], s25 offen sc1
 s_waitcnt vmcnt(0)
 v_xad_u32 v4, v176, v177, s61
 v_add3_u32 v4, v4, v178, v179
 v_xad_u32 v4, v180, v181, v4
 v_add3_u32 v4, v4, v182, v183
 v_xad_u32 v4, v184, v185, v4
 v_add3_u32 v4, v4, v186, v187
 v_xad_u32 v4, v188, v189, v4
 v_add3_u32 v4, v4, v190, v191
 v_cmp_ne_u32 vcc, v4, v210
 s_cbranch_vccnz L_hh1_2_r
 buffer_load_dwordx4 v[192:195], v6, s[48:51], s26 offen offset:0 sc1
 buffer_load_dwordx4 v[196:199], v6, s[48:51], s26 offen offset:1024 sc1
 buffer_load_dwordx4 v[200:203], v6, s[48:51], s26 offen offset:2048 sc1
 buffer_load_dwordx4 v[204:207], v6, s[48:51], s26 offen offset:3072 sc1
 buffer_load_dword v211, v2, s[48:51], s26 offen sc1
 buffer_load_dwordx4 v[224:227], v6, s[48:51], s27 offen offset:0 sc1
 buffer_load_dwordx4 v[228:231], v6, s[48:51], s27 offen offset:1024 sc1
 buffer_load_dwordx4 v[232:235], v6, s[48:51], s27 offen offset:2048 sc1
 buffer_load_dwordx4 v[236:239], v6, s[48:51], s27 offen offset:3072 sc1
 buffer_load_dword v219, v2, s[48:51], s27 offen sc1
 s_waitcnt vmcnt(0)
 s_branch L_hh1_2_b
L_hh1_2_x:
 s_mov_b32 s75, 0
 s_branch L_hh1_2_b
L_hh1_3_r:
 s_sub_u32 s75, s75, 1
 s_cbranch_scc1 L_hh1_3_x
 s_sleep 4
 buffer_load_dwordx4 v[192:195], v6, s[48:51], s26 offen offset:0 sc1
 buffer_load_dwordx4 v[196:199], v6, s[48:51], s26 offen offset:1024 sc1
 buffer_load_dwordx4 v[200:203], v6, s[48:51], s26 offen offset:2048 sc1
 buffer_load_dwordx4 v[204:207], v6, s[48:51], s26 offen offset:3072 sc1
 buffer_load_dword v211, v2, s[48:51], s26 offen sc1
 s_waitcnt vmcnt(0)
 v_xad_u32 v4, v192, v193, s61
 v_add3_u32 v4, v4, v194, v195
 v_xad_u32 v4, v196, v197, v4
 v_add3_u32 v4, v4, v198, v199
 v_xad_u32 v4, v200, v201, v4
 v_add3_u32 v4, v4, v202, v203
 v_xad_u32 v4, v204, v205, v4
 v_add3_u32 v4, v4, v206, v207
 v_cmp_ne_u32 vcc, v4, v211
 s_cbranch_vccnz L_hh1_3_r
 buffer_load_dwordx4 v[224:227], v6, s[48:51], s27 offen offset:0 sc1
 buffer_load_dwordx4 v[228:231], v6, s[48:51], s27 offen offset:1024 sc1
 buffer_load_dwordx4 v[232:235], v6, s[48:51], s27 offen offset:2048 sc1
 buffer_load_dwordx4 v[236:239], v6, s[48:51], s27 offen offset:3072 sc1
 buffer_load_dword v219, v2, s[48:51], s27 offen sc1
 buffer_load_dwordx4 v[80:83], v6, s[48:51], s28 offen offset:0 sc1
 buffer_load_dwordx4 v[84:87], v6, s[48:51], s28 offen offset:1024 sc1
 buffer_load_dwordx4 v[88:91], v6, s[48:51], s28 offen offset:2048 sc1
 buffer_load_dwordx4 v[92:95], v6, s[48:51], s28 offen offset:3072 sc1
 buffer_load_dword v248, v2, s[48:51], s28 offen sc1
 s_waitcnt vmcnt(0)
 s_branch L_hh1_3_b
L_hh1_3_x:
 s_mov_b32 s75, 0
 s_branch L_hh1_3_b
L_hh1_4_r:
 s_sub_u32 s75, s75, 1
 s_cbranch_scc1 L_hh1_4_x
 s_sleep 4
 buffer_load_dwordx4 v[224:227], v6, s[48:51], s27 offen offset:0 sc1
 buffer_load_dwordx4 v[228:231], v6, s[48:51], s27 offen offset:1024 sc1
 buffer_load_dwordx4 v[232:235], v6, s[48:51], s27 offen offset:2048 sc1
 buffer_load_dwordx4 v[236:239], v6, s[48:51], s27 offen offset:3072 sc1
 buffer_load_dword v219, v2, s[48:51], s27 offen sc1
 s_waitcnt vmcnt(0)
 v_xad_u32 v4, v224, v225, s61
 v_add3_u32 v4, v4, v226, v227
 v_xad_u32 v4, v228, v229, v4
 v_add3_u32 v4, v4, v230, v231
 v_xad_u32 v4, v232, v233, v4
 v_add3_u32 v4, v4, v234, v235
 v_xad_u32 v4, v236, v237, v4
 v_add3_u32 v4, v4, v238, v239
 v_cmp_ne_u32 vcc, v4, v219
 s_cbranch_vccnz L_hh1_4_r
 buffer_load_dwordx4 v[80:83], v6, s[48:51], s28 offen offset:0 sc1
 buffer_load_dwordx4 v[84:87], v6, s[48:51], s28 offen offset:1024 sc1
 buffer_load_dwordx4 v[88:91], v6, s[48:51], s28 offen offset:2048 sc1
 buffer_load_dwordx4 v[92:95], v6, s[48:51], s28 offen offset:3072 sc1
 buffer_load_dword v248, v2, s[48:51], s28 offen sc1
 buffer_load_dwordx4 v[96:99], v6, s[48:51], s29 offen offset:0 sc1
 buffer_load_dwordx4 v[100:103], v6, s[48:51], s29 offen offset:1024 sc1
 buffer_load_dwordx4 v[104:107], v6, s[48:51], s29 offen offset:2048 sc1
 buffer_load_dwordx4 v[108:111], v6, s[48:51], s29 offen offset:3072 sc1
 buffer_load_dword v212, v2, s[48:51], s29 offen sc1
 s_waitcnt vmcnt(0)
 s_branch L_hh1_4_b
L_hh1_4_x:
 s_mov_b32 s75, 0
 s_branch L_hh1_4_b
L_hh1_5_r:
 s_sub_u32 s75, s75, 1
 s_cbranch_scc1 L_hh1_5_x
 s_sleep 4
 buffer_load_dwordx4 v[80:83], v6, s[48:51], s28 offen offset:0 sc1
 buffer_load_dwordx4 v[84:87], v6, s[48:51], s28 offen offset:1024 sc1
 buffer_load_dwordx4 v[88:91], v6, s[48:51], s28 offen offset:2048 sc1
 buffer_load_dwordx4 v[92:95], v6, s[48:51], s28 offen offset:3072 sc1
 buffer_load_dword v248, v2, s[48:51], s28 offen sc1
 s_waitcnt vmcnt(0)
 v_xad_u32 v4, v80, v81, s61
 v_add3_u32 v4, v4, v82, v83
 v_xad_u32 v4, v84, v85, v4
 v_add3_u32 v4, v4, v86, v87
 v_xad_u32 v4, v88, v89, v4
 v_add3_u32 v4, v4, v90, v91
 v_xad_u32 v4, v92, v93, v4
 v_add3_u32 v4, v4, v94, v95
 v_cmp_ne_u32 vcc, v4, v248
 s_cbranch_vccnz L_hh1_5_r
 buffer_load_dwordx4 v[96:99], v6, s[48:51], s29 offen offset:0 sc1
 buffer_load_dwordx4 v[100:103], v6, s[48:51], s29 offen offset:1024 sc1
 buffer_load_dwordx4 v[104:107], v6, s[48:51], s29 offen offset:2048 sc1
 buffer_load_dwordx4 v[108:111], v6, s[48:51], s29 offen offset:3072 sc1
 buffer_load_dword v212, v2, s[48:51], s29 offen sc1
 s_waitcnt vmcnt(0)
 s_branch L_hh1_5_b
L_hh1_5_x:
 s_mov_b32 s75, 0
 s_branch L_hh1_5_b
L_hh1_6_r:
 s_sub_u32 s75, s75, 1
 s_cbranch_scc1 L_hh1_6_x
 s_sleep 4
 buffer_load_dwordx4 v[96:99], v6, s[48:51], s29 offen offset:0 sc1
 buffer_load_dwordx4 v[100:103], v6, s[48:51], s29 offen offset:1024 sc1
 buffer_load_dwordx4 v[104:107], v6, s[48:51], s29 offen offset:2048 sc1
 buffer_load_dwordx4 v[108:111], v6, s[48:51], s29 offen offset:3072 sc1
 buffer_load_dword v212, v2, s[48:51], s29 offen sc1
 s_waitcnt vmcnt(0)
 v_xad_u32 v4, v96, v97, s61
 v_add3_u32 v4, v4, v98, v99
 v_xad_u32 v4, v100, v101, v4
 v_add3_u32 v4, v4, v102, v103
 v_xad_u32 v4, v104, v105, v4
 v_add3_u32 v4, v4, v106, v107
 v_xad_u32 v4, v108, v109, v4
 v_add3_u32 v4, v4, v110, v111
 v_cmp_ne_u32 vcc, v4, v212
 s_cbranch_vccnz L_hh1_6_r
 s_branch L_hh1_6_b
L_hh1_6_x:
 s_mov_b32 s75, 0
 s_branch L_hh1_6_b
L_codeend:
 s_endpgm
.section .rodata,"a"
.p2align 6
.amdhsa_kernel sequential_preLN__ssm_conv_h3__glu_gated_glu__prompt_kernel
  .amdhsa_next_free_vgpr 512
  .amdhsa_next_free_sgpr 102
  .amdhsa_accum_offset 256
  .amdhsa_group_segment_fixed_size 0
  .amdhsa_kernarg_size 104
  .amdhsa_user_sgpr_count 2
  .amdhsa_user_sgpr_kernarg_segment_ptr 1
  .amdhsa_system_sgpr_workgroup_id_x 1
.end_amdhsa_kernel
```
